```python
import torch

def _softmax(x, axis=-1):
    return torch.softmax(x, dim=axis)
def _gelu(x):
    return torch.nn.functional.gelu(x, approximate="tanh")
def _silu(x):
    return torch.nn.functional.silu(x)
def _sigmoid(x):
    return torch.sigmoid(x)
def _layernorm(x, axis=-1, eps=1e-5):
    m = x.mean(dim=axis, keepdim=True)
    v = x.var(dim=axis, keepdim=True, unbiased=False)
    return (x - m) / torch.sqrt(v + eps)
def _scatter_add(tgt, idx, src, axis=0):
    return tgt.clone().index_add_(axis, idx, src)
def _segment_sum(src, seg, n):
    out = torch.zeros((n,) + src.shape[1:], dtype=src.dtype)
    return out.index_add_(0, seg, src)
def _pad(x, pw):
    flat = tuple(v for pair in reversed(pw) for v in pair)
    return torch.nn.functional.pad(x, flat)

kernel_name = 'standalone__mha_softmax__near_ridge'

def setup_inputs():

    _w = (lambda a: (lambda t: t.to(torch.bfloat16) if t.is_floating_point() else t)(torch.as_tensor(a)))
    B, H, Sq, Sk, D = 8, 32, 256, 512, 128
    return {
        "q": _w((lambda *s: torch.randn(*s, dtype=torch.bfloat16) * 0.8)(B, H, Sq, D)),
        "k": _w((lambda *s: torch.randn(*s, dtype=torch.bfloat16) * 0.8)(B, H, Sk, D)),
        "v": _w((lambda *s: torch.randn(*s, dtype=torch.bfloat16) * 0.05)(B, H, Sk, D)),
    }

def reference(q, k, v):
    scale = q.shape[-1] ** -0.5
    scores = torch.einsum("bhqd,bhkd->bhqk", q, k) * scale
    p = _softmax(scores, axis=-1)
    return torch.einsum("bhqk,bhkd->bhqd", p, v)
```

```asm
; @launch grid=(256,1,1) block=(256,1,1) lds=155648
.amdgcn_target "amdgcn-amd-amdhsa--gfx950"
.text
.globl standalone__mha_softmax__near_ridge_kernel
.p2align 8
.type standalone__mha_softmax__near_ridge_kernel,@function
standalone__mha_softmax__near_ridge_kernel:
    s_cmp_ge_u32 s2, 256
    s_cbranch_scc1 L_end
    s_load_dwordx8 s[4:11], s[0:1], 0
    v_lshrrev_b32_e32 v232, 6, v0
    v_and_b32_e32 v223, 63, v0
    v_readfirstlane_b32 s28, v232
    v_lshrrev_b32_e32 v233, 4, v223
    v_and_b32_e32 v234, 15, v0
    v_xor_b32_e32 v235, v233, v234
    v_lshlrev_b32_e32 v235, 4, v235
    v_lshl_add_u32 v222, v233, 8, v235
    v_lshlrev_b32_e32 v243, 4, v223
    s_and_b32 s29, s2, 7
    s_lshl_b32 s29, s29, 5
    s_lshr_b32 s38, s2, 3
    s_or_b32 s29, s29, s38
    s_lshl_b32 s30, s28, 10
    s_mul_i32 s38, s28, 1088
    v_xor_b32_e32 v220, s38, v222
    s_lshl_b32 s38, s29, 17
    s_lshl_b32 s39, s29, 16
    s_mov_b32 s14, 131072
    s_mov_b32 s15, 0x20000
    s_mov_b32 s18, 65536
    s_mov_b32 s19, 0x20000
    s_lshl_b32 s32, s28, 14
    s_movk_i32 s36, 4096
    s_add_u32 m0, s30, 0
    s_waitcnt lgkmcnt(0)
    s_add_u32 s12, s6, s38
    s_addc_u32 s13, s7, 0
    buffer_load_dwordx4 v220, s[12:15], 0 offen nt lds
    s_add_u32 m0, s30, 4096
    s_add_u32 s16, s4, s39
    buffer_load_dwordx4 v220, s[12:15], s36 offen nt lds
    s_addc_u32 s17, s5, 0
    s_add_u32 s31, s32, 90112
    s_add_u32 s33, s32, 4096
    s_add_u32 s34, s32, 8192
    s_add_u32 s35, s32, 12288
    v_lshlrev_b32_e32 v248, 7, v0
    buffer_load_dwordx4 v[64:67], v243, s[16:19], s32 offen nt
    buffer_load_dwordx4 v[68:71], v243, s[16:19], s32 offen offset:1024 nt
    s_barrier
    buffer_load_dwordx4 v[72:75], v243, s[16:19], s32 offen offset:2048 nt
    buffer_load_dwordx4 v[76:79], v243, s[16:19], s32 offen offset:3072 nt
    s_barrier
    s_add_u32 m0, s30, 8192
    s_mov_b32 s36, 8192
    buffer_load_dwordx4 v220, s[12:15], s36 offen nt lds
    s_add_u32 m0, s30, 12288
    s_mov_b32 s37, 12288
    buffer_load_dwordx4 v220, s[12:15], s37 offen nt lds
    buffer_load_dwordx4 v[80:83], v243, s[16:19], s33 offen nt
    buffer_load_dwordx4 v[84:87], v243, s[16:19], s33 offen offset:1024 nt
    s_barrier
    buffer_load_dwordx4 v[88:91], v243, s[16:19], s33 offen offset:2048 nt
    buffer_load_dwordx4 v[92:95], v243, s[16:19], s33 offen offset:3072 nt
    s_barrier
    buffer_load_dwordx4 v[96:99], v243, s[16:19], s34 offen nt
    buffer_load_dwordx4 v[100:103], v243, s[16:19], s34 offen offset:1024 nt
    s_add_u32 s20, s8, s38
    s_addc_u32 s21, s9, 0
    s_mov_b32 s22, 131072
    s_mov_b32 s23, 0x20000
    s_add_u32 s24, s10, s39
    s_addc_u32 s25, s11, 0
    v_lshlrev_b32_e32 v236, 1, v233
    v_xor_b32_e32 v236, v236, v234
    v_lshlrev_b32_e32 v236, 4, v236
    v_lshl_add_u32 v236, v233, 8, v236
    s_and_b32 s38, s28, 1
    s_lshl_b32 s38, s38, 7
    s_or_b32 s38, s38, s30
    v_xor_b32_e32 v221, s38, v236
    s_mov_b32 s26, 65536
    s_mov_b32 s27, 0x20000
    v_lshl_add_u32 v208, v234, 8, v235
    v_xor_b32_e32 v209, 64, v208
    v_xor_b32_e32 v210, 128, v208
    v_xor_b32_e32 v211, 192, v208
    v_add_u32_e32 v244, s31, v208
    v_add_u32_e32 v245, s31, v209
    v_add_u32_e32 v246, s31, v210
    v_add_u32_e32 v247, s31, v211
    v_lshrrev_b32_e32 v236, 2, v234
    v_mul_u32_u24_e32 v236, 288, v236
    v_lshl_add_u32 v236, v233, 10, v236
    v_and_b32_e32 v237, 1, v233
    v_lshl_add_u32 v236, v237, 7, v236
    v_and_b32_e32 v237, 3, v223
    v_lshl_add_u32 v236, v237, 3, v236
    v_add_u32_e32 v212, 49152, v236
    v_xor_b32_e32 v213, 32, v212
    v_xor_b32_e32 v214, 64, v212
    v_xor_b32_e32 v215, 96, v212
    v_xor_b32_e32 v216, 128, v212
    v_xor_b32_e32 v217, 160, v212
    v_xor_b32_e32 v218, 192, v212
    v_xor_b32_e32 v219, 224, v212
    v_add_u32_e32 v241, s31, v222
    v_xor_b32_e32 v242, 64, v241
    v_xor_b32_e32 v228, 0, v241
    v_xor_b32_e32 v229, 64, v241
    v_xor_b32_e32 v230, 128, v241
    v_xor_b32_e32 v231, 192, v241
    v_mov_b32_e32 v251, 0x3e0293ee
    v_mov_b32_e32 v224, 0x3f803f80
    v_accvgpr_write_b32 a240, v224
    v_accvgpr_write_b32 a241, v224
    v_accvgpr_write_b32 a242, v224
    v_accvgpr_write_b32 a243, v224
    s_waitcnt vmcnt(12)
    s_barrier
    ds_read_b128 a[64:67], v208
    ds_read_b128 a[68:71], v209
    ds_read_b128 a[72:75], v210
    ds_read_b128 a[76:79], v211
    ds_read_b128 a[80:83], v208 offset:4096
    ds_read_b128 a[84:87], v209 offset:4096
    ds_read_b128 a[88:91], v210 offset:4096
    ds_read_b128 a[92:95], v211 offset:4096
    s_waitcnt vmcnt(11)
    v_lshlrev_b32_e32 v234, 16, v64
    v_and_b32_e32 v235, 0xffff0000, v64
    v_lshlrev_b32_e32 v236, 16, v65
    v_and_b32_e32 v237, 0xffff0000, v65
    v_lshlrev_b32_e32 v238, 16, v66
    v_and_b32_e32 v239, 0xffff0000, v66
    v_lshlrev_b32_e32 v252, 16, v67
    v_and_b32_e32 v253, 0xffff0000, v67
    v_mul_f32_e32 v234, v251, v234
    v_mul_f32_e32 v235, v251, v235
    v_mul_f32_e32 v236, v251, v236
    v_mul_f32_e32 v237, v251, v237
    v_mul_f32_e32 v238, v251, v238
    v_mul_f32_e32 v239, v251, v239
    v_mul_f32_e32 v252, v251, v252
    v_mul_f32_e32 v253, v251, v253
    v_cvt_pk_bf16_f32 v64, v234, v235
    v_cvt_pk_bf16_f32 v65, v236, v237
    v_cvt_pk_bf16_f32 v66, v238, v239
    v_cvt_pk_bf16_f32 v67, v252, v253
    ds_write_b128 v228, v[64:67]
    s_add_u32 m0, s30, 49152
    s_mov_b32 s38, 0
    buffer_load_dwordx4 v221, s[20:23], s38 offen nt lds
    s_waitcnt vmcnt(11)
    v_lshlrev_b32_e32 v234, 16, v68
    v_and_b32_e32 v235, 0xffff0000, v68
    v_lshlrev_b32_e32 v236, 16, v69
    v_and_b32_e32 v237, 0xffff0000, v69
    v_lshlrev_b32_e32 v238, 16, v70
    v_and_b32_e32 v239, 0xffff0000, v70
    v_lshlrev_b32_e32 v252, 16, v71
    v_and_b32_e32 v253, 0xffff0000, v71
    v_mul_f32_e32 v234, v251, v234
    v_mul_f32_e32 v235, v251, v235
    v_mul_f32_e32 v236, v251, v236
    v_mul_f32_e32 v237, v251, v237
    v_mul_f32_e32 v238, v251, v238
    v_mul_f32_e32 v239, v251, v239
    v_mul_f32_e32 v252, v251, v252
    v_mul_f32_e32 v253, v251, v253
    v_cvt_pk_bf16_f32 v68, v234, v235
    v_cvt_pk_bf16_f32 v69, v236, v237
    v_cvt_pk_bf16_f32 v70, v238, v239
    v_cvt_pk_bf16_f32 v71, v252, v253
    ds_write_b128 v229, v[68:71] offset:1024
    s_add_u32 m0, s30, 53248
    s_mov_b32 s39, 4096
    buffer_load_dwordx4 v221, s[20:23], s39 offen nt lds
    s_waitcnt vmcnt(11)
    v_lshlrev_b32_e32 v234, 16, v72
    v_and_b32_e32 v235, 0xffff0000, v72
    v_lshlrev_b32_e32 v236, 16, v73
    v_and_b32_e32 v237, 0xffff0000, v73
    v_lshlrev_b32_e32 v238, 16, v74
    v_and_b32_e32 v239, 0xffff0000, v74
    v_lshlrev_b32_e32 v252, 16, v75
    v_and_b32_e32 v253, 0xffff0000, v75
    v_mul_f32_e32 v234, v251, v234
    v_mul_f32_e32 v235, v251, v235
    v_mul_f32_e32 v236, v251, v236
    v_mul_f32_e32 v237, v251, v237
    v_mul_f32_e32 v238, v251, v238
    v_mul_f32_e32 v239, v251, v239
    v_mul_f32_e32 v252, v251, v252
    v_mul_f32_e32 v253, v251, v253
    v_cvt_pk_bf16_f32 v72, v234, v235
    v_cvt_pk_bf16_f32 v73, v236, v237
    v_cvt_pk_bf16_f32 v74, v238, v239
    v_cvt_pk_bf16_f32 v75, v252, v253
    ds_write_b128 v230, v[72:75] offset:2048
    buffer_load_dwordx4 v[104:107], v243, s[16:19], s34 offen offset:2048 nt
    s_waitcnt vmcnt(11)
    v_lshlrev_b32_e32 v234, 16, v76
    v_and_b32_e32 v235, 0xffff0000, v76
    v_lshlrev_b32_e32 v236, 16, v77
    v_and_b32_e32 v237, 0xffff0000, v77
    v_lshlrev_b32_e32 v238, 16, v78
    v_and_b32_e32 v239, 0xffff0000, v78
    v_lshlrev_b32_e32 v252, 16, v79
    v_and_b32_e32 v253, 0xffff0000, v79
    v_mul_f32_e32 v234, v251, v234
    v_mul_f32_e32 v235, v251, v235
    v_mul_f32_e32 v236, v251, v236
    v_mul_f32_e32 v237, v251, v237
    v_mul_f32_e32 v238, v251, v238
    v_mul_f32_e32 v239, v251, v239
    v_mul_f32_e32 v252, v251, v252
    v_mul_f32_e32 v253, v251, v253
    v_cvt_pk_bf16_f32 v76, v234, v235
    v_cvt_pk_bf16_f32 v77, v236, v237
    v_cvt_pk_bf16_f32 v78, v238, v239
    v_cvt_pk_bf16_f32 v79, v252, v253
    ds_write_b128 v231, v[76:79] offset:3072
    ds_read_b128 a[0:3], v244
    ds_read_b128 a[4:7], v245
    ds_read_b128 a[8:11], v246
    ds_read_b128 a[12:15], v247
    buffer_load_dwordx4 v[108:111], v243, s[16:19], s34 offen offset:3072 nt
    s_waitcnt vmcnt(9)
    s_waitcnt lgkmcnt(0)
    v_mfma_f32_16x16x32_bf16 v[128:131], a[64:67], a[0:3], 0
    v_lshlrev_b32_e32 v234, 16, v80
    v_and_b32_e32 v235, 0xffff0000, v80
    v_lshlrev_b32_e32 v236, 16, v81
    v_mfma_f32_16x16x32_bf16 v[128:131], a[68:71], a[4:7], v[128:131]
    v_and_b32_e32 v237, 0xffff0000, v81
    v_lshlrev_b32_e32 v238, 16, v82
    v_and_b32_e32 v239, 0xffff0000, v82
    v_mfma_f32_16x16x32_bf16 v[128:131], a[72:75], a[8:11], v[128:131]
    v_lshlrev_b32_e32 v252, 16, v83
    v_and_b32_e32 v253, 0xffff0000, v83
    v_mul_f32_e32 v234, v251, v234
    v_mfma_f32_16x16x32_bf16 v[128:131], a[76:79], a[12:15], v[128:131]
    v_mul_f32_e32 v235, v251, v235
    v_mul_f32_e32 v236, v251, v236
    v_mul_f32_e32 v237, v251, v237
    v_mfma_f32_16x16x32_bf16 v[132:135], a[80:83], a[0:3], 0
    v_mul_f32_e32 v238, v251, v238
    v_mul_f32_e32 v239, v251, v239
    v_mfma_f32_16x16x32_bf16 v[132:135], a[84:87], a[4:7], v[132:135]
    v_mul_f32_e32 v252, v251, v252
    v_mul_f32_e32 v253, v251, v253
    v_mfma_f32_16x16x32_bf16 v[132:135], a[88:91], a[8:11], v[132:135]
    v_cvt_pk_bf16_f32 v80, v234, v235
    v_cvt_pk_bf16_f32 v81, v236, v237
    v_mfma_f32_16x16x32_bf16 v[132:135], a[92:95], a[12:15], v[132:135]
    v_cvt_pk_bf16_f32 v82, v238, v239
    v_cvt_pk_bf16_f32 v83, v252, v253
    ds_write_b128 v228, v[80:83] offset:4096
    buffer_load_dwordx4 v[112:115], v243, s[16:19], s35 offen nt
    s_waitcnt vmcnt(9)
    v_lshlrev_b32_e32 v234, 16, v84
    v_and_b32_e32 v235, 0xffff0000, v84
    v_lshlrev_b32_e32 v236, 16, v85
    v_and_b32_e32 v237, 0xffff0000, v85
    v_lshlrev_b32_e32 v238, 16, v86
    v_and_b32_e32 v239, 0xffff0000, v86
    v_lshlrev_b32_e32 v252, 16, v87
    v_and_b32_e32 v253, 0xffff0000, v87
    v_mul_f32_e32 v234, v251, v234
    v_mul_f32_e32 v235, v251, v235
    v_mul_f32_e32 v236, v251, v236
    v_mul_f32_e32 v237, v251, v237
    v_mul_f32_e32 v238, v251, v238
    v_mul_f32_e32 v239, v251, v239
    v_mul_f32_e32 v252, v251, v252
    v_mul_f32_e32 v253, v251, v253
    v_cvt_pk_bf16_f32 v84, v234, v235
    v_cvt_pk_bf16_f32 v85, v236, v237
    v_cvt_pk_bf16_f32 v86, v238, v239
    v_cvt_pk_bf16_f32 v87, v252, v253
    ds_write_b128 v229, v[84:87] offset:5120
    buffer_load_dwordx4 v[116:119], v243, s[16:19], s35 offen offset:1024 nt
    v_max3_f32 v232, v128, v129, v130
    v_max3_f32 v233, v131, v132, v133
    v_max3_f32 v232, v232, v134, v135
    v_max_f32_e32 v232, v232, v233
    v_mov_b32_e32 v233, v232
    s_nop 1
    v_permlane16_swap_b32 v232, v233
    v_max_f32_e32 v232, v232, v233
    v_mov_b32_e32 v233, v232
    s_nop 1
    v_permlane32_swap_b32 v232, v233
    v_min_f32_e64 v192, -v232, -v233
    v_mov_b32_e32 v193, v192
    v_mov_b32_e32 v194, v192
    v_mov_b32_e32 v195, v192
    s_waitcnt vmcnt(12)
    s_barrier
    ds_read_b128 a[128:131], v208 offset:8192
    ds_read_b128 a[132:135], v209 offset:8192
    ds_read_b128 a[136:139], v210 offset:8192
    ds_read_b128 a[140:143], v211 offset:8192
    ds_read_b128 a[144:147], v208 offset:12288
    ds_read_b128 a[148:151], v209 offset:12288
    ds_read_b128 a[152:155], v210 offset:12288
    ds_read_b128 a[156:159], v211 offset:12288
    s_waitcnt vmcnt(9)
    v_lshlrev_b32_e32 v234, 16, v88
    v_and_b32_e32 v235, 0xffff0000, v88
    v_lshlrev_b32_e32 v236, 16, v89
    v_and_b32_e32 v237, 0xffff0000, v89
    v_lshlrev_b32_e32 v238, 16, v90
    v_and_b32_e32 v239, 0xffff0000, v90
    v_lshlrev_b32_e32 v252, 16, v91
    v_and_b32_e32 v253, 0xffff0000, v91
    v_mul_f32_e32 v234, v251, v234
    v_mul_f32_e32 v235, v251, v235
    v_mul_f32_e32 v236, v251, v236
    v_mul_f32_e32 v237, v251, v237
    v_mul_f32_e32 v238, v251, v238
    v_mul_f32_e32 v239, v251, v239
    v_mul_f32_e32 v252, v251, v252
    v_mul_f32_e32 v253, v251, v253
    v_cvt_pk_bf16_f32 v88, v234, v235
    v_cvt_pk_bf16_f32 v89, v236, v237
    v_cvt_pk_bf16_f32 v90, v238, v239
    v_cvt_pk_bf16_f32 v91, v252, v253
    ds_write_b128 v230, v[88:91] offset:6144
    buffer_load_dwordx4 v[120:123], v243, s[16:19], s35 offen offset:2048 nt
    v_add_f32_e32 v128, v192, v128
    v_exp_f32_e32 v128, v128
    v_add_f32_e32 v129, v192, v129
    v_exp_f32_e32 v129, v129
    v_add_f32_e32 v130, v192, v130
    v_exp_f32_e32 v130, v130
    v_cvt_pk_bf16_f32 v160, v128, v129
    v_add_f32_e32 v131, v192, v131
    v_exp_f32_e32 v131, v131
    v_add_f32_e32 v132, v192, v132
    v_exp_f32_e32 v132, v132
    v_cvt_pk_bf16_f32 v161, v130, v131
    v_add_f32_e32 v133, v192, v133
    v_exp_f32_e32 v133, v133
    v_add_f32_e32 v134, v192, v134
    v_exp_f32_e32 v134, v134
    v_cvt_pk_bf16_f32 v162, v132, v133
    v_add_f32_e32 v135, v192, v135
    v_exp_f32_e32 v135, v135
    s_nop 0
    v_cvt_pk_bf16_f32 v163, v134, v135
    s_waitcnt vmcnt(9)
    s_waitcnt lgkmcnt(1)
    v_mfma_f32_16x16x32_bf16 v[128:131], a[128:131], a[0:3], v[192:195]
    v_lshlrev_b32_e32 v234, 16, v92
    v_and_b32_e32 v235, 0xffff0000, v92
    v_lshlrev_b32_e32 v236, 16, v93
    v_mfma_f32_16x16x32_bf16 v[128:131], a[132:135], a[4:7], v[128:131]
    v_and_b32_e32 v237, 0xffff0000, v93
    v_lshlrev_b32_e32 v238, 16, v94
    v_and_b32_e32 v239, 0xffff0000, v94
    v_mfma_f32_16x16x32_bf16 v[128:131], a[136:139], a[8:11], v[128:131]
    v_lshlrev_b32_e32 v252, 16, v95
    v_and_b32_e32 v253, 0xffff0000, v95
    v_mul_f32_e32 v234, v251, v234
    v_mfma_f32_16x16x32_bf16 v[128:131], a[140:143], a[12:15], v[128:131]
    v_mul_f32_e32 v235, v251, v235
    v_mul_f32_e32 v236, v251, v236
    v_mul_f32_e32 v237, v251, v237
    v_mfma_f32_16x16x32_bf16 v[132:135], a[144:147], a[0:3], v[192:195]
    v_mul_f32_e32 v238, v251, v238
    v_mul_f32_e32 v239, v251, v239
    v_mfma_f32_16x16x32_bf16 v[132:135], a[148:151], a[4:7], v[132:135]
    v_mul_f32_e32 v252, v251, v252
    v_mul_f32_e32 v253, v251, v253
    v_mfma_f32_16x16x32_bf16 v[132:135], a[152:155], a[8:11], v[132:135]
    v_cvt_pk_bf16_f32 v92, v234, v235
    v_cvt_pk_bf16_f32 v93, v236, v237
    v_mfma_f32_16x16x32_bf16 v[132:135], a[156:159], a[12:15], v[132:135]
    v_cvt_pk_bf16_f32 v94, v238, v239
    v_cvt_pk_bf16_f32 v95, v252, v253
    ds_write_b128 v231, v[92:95] offset:7168
    ds_read_b128 a[16:19], v244 offset:4096
    ds_read_b128 a[20:23], v245 offset:4096
    ds_read_b128 a[24:27], v246 offset:4096
    ds_read_b128 a[28:31], v247 offset:4096
    buffer_load_dwordx4 v[124:127], v243, s[16:19], s35 offen offset:3072 nt
    s_waitcnt vmcnt(9)
    s_waitcnt lgkmcnt(0)
    v_mfma_f32_16x16x32_bf16 v[136:139], a[64:67], a[16:19], 0
    v_lshlrev_b32_e32 v234, 16, v96
    v_and_b32_e32 v235, 0xffff0000, v96
    v_lshlrev_b32_e32 v236, 16, v97
    v_mfma_f32_16x16x32_bf16 v[136:139], a[68:71], a[20:23], v[136:139]
    v_and_b32_e32 v237, 0xffff0000, v97
    v_lshlrev_b32_e32 v238, 16, v98
    v_and_b32_e32 v239, 0xffff0000, v98
    v_mfma_f32_16x16x32_bf16 v[136:139], a[72:75], a[24:27], v[136:139]
    v_lshlrev_b32_e32 v252, 16, v99
    v_and_b32_e32 v253, 0xffff0000, v99
    v_mul_f32_e32 v234, v251, v234
    v_mfma_f32_16x16x32_bf16 v[136:139], a[76:79], a[28:31], v[136:139]
    v_mul_f32_e32 v235, v251, v235
    v_mul_f32_e32 v236, v251, v236
    v_mul_f32_e32 v237, v251, v237
    v_mfma_f32_16x16x32_bf16 v[140:143], a[80:83], a[16:19], 0
    v_mul_f32_e32 v238, v251, v238
    v_mul_f32_e32 v239, v251, v239
    v_mfma_f32_16x16x32_bf16 v[140:143], a[84:87], a[20:23], v[140:143]
    v_mul_f32_e32 v252, v251, v252
    v_mul_f32_e32 v253, v251, v253
    v_mfma_f32_16x16x32_bf16 v[140:143], a[88:91], a[24:27], v[140:143]
    v_cvt_pk_bf16_f32 v96, v234, v235
    v_cvt_pk_bf16_f32 v97, v236, v237
    v_mfma_f32_16x16x32_bf16 v[140:143], a[92:95], a[28:31], v[140:143]
    v_cvt_pk_bf16_f32 v98, v238, v239
    v_cvt_pk_bf16_f32 v99, v252, v253
    ds_write_b128 v228, v[96:99] offset:8192
    s_getpc_b64 s[96:97]
L_pc:
    s_sub_u32 s96, s96, L_pc-standalone__mha_softmax__near_ridge_kernel
    s_subb_u32 s97, s97, 0
    v_min_u32_e32 v248, L_safe-standalone__mha_softmax__near_ridge_kernel-4, v248
    v_mov_b32_e32 v249, s97
    v_add_co_u32_e32 v248, vcc, s96, v248
    s_nop 1
    v_addc_co_u32_e32 v249, vcc, 0, v249, vcc
    global_load_dword v250, v[248:249], off
    v_exp_f32_e32 v128, v128
    v_exp_f32_e32 v129, v129
    v_exp_f32_e32 v130, v130
    v_cvt_pk_bf16_f32 v176, v128, v129
    v_exp_f32_e32 v131, v131
    v_exp_f32_e32 v132, v132
    v_cvt_pk_bf16_f32 v177, v130, v131
    v_exp_f32_e32 v133, v133
    v_exp_f32_e32 v134, v134
    v_cvt_pk_bf16_f32 v178, v132, v133
    v_exp_f32_e32 v135, v135
    s_nop 0
    v_cvt_pk_bf16_f32 v179, v134, v135
    s_waitcnt vmcnt(7)
    s_barrier
    ds_read_b64_tr_b16 a[96:97], v212
    ds_read_b64_tr_b16 a[98:99], v212 offset:4096
    ds_read_b64_tr_b16 a[100:101], v213
    ds_read_b64_tr_b16 a[102:103], v213 offset:4096
    ds_read_b64_tr_b16 a[104:105], v214
    ds_read_b64_tr_b16 a[106:107], v214 offset:4096
    ds_read_b64_tr_b16 a[108:109], v215
    ds_read_b64_tr_b16 a[110:111], v215 offset:4096
    ds_read_b64_tr_b16 a[112:113], v216
    ds_read_b64_tr_b16 a[114:115], v216 offset:4096
    ds_read_b64_tr_b16 a[116:117], v217
    ds_read_b64_tr_b16 a[118:119], v217 offset:4096
    ds_read_b64_tr_b16 a[120:121], v218
    ds_read_b64_tr_b16 a[122:123], v218 offset:4096
    ds_read_b64_tr_b16 a[124:125], v219
    ds_read_b64_tr_b16 a[126:127], v219 offset:4096
    s_waitcnt vmcnt(9)
    s_waitcnt lgkmcnt(0)
    v_mfma_f32_16x16x32_bf16 a[224:227], a[240:243], v[160:163], 0
    v_lshlrev_b32_e32 v234, 16, v100
    v_and_b32_e32 v235, 0xffff0000, v100
    v_lshlrev_b32_e32 v236, 16, v101
    v_mfma_f32_16x16x32_bf16 v[0:3], a[96:99], v[160:163], 0
    v_and_b32_e32 v237, 0xffff0000, v101
    v_lshlrev_b32_e32 v238, 16, v102
    v_and_b32_e32 v239, 0xffff0000, v102
    v_mfma_f32_16x16x32_bf16 v[4:7], a[100:103], v[160:163], 0
    v_lshlrev_b32_e32 v252, 16, v103
    v_and_b32_e32 v253, 0xffff0000, v103
    v_mfma_f32_16x16x32_bf16 v[8:11], a[104:107], v[160:163], 0
    v_mul_f32_e32 v234, v251, v234
    v_mul_f32_e32 v235, v251, v235
    v_mfma_f32_16x16x32_bf16 v[12:15], a[108:111], v[160:163], 0
    v_mul_f32_e32 v236, v251, v236
    v_mul_f32_e32 v237, v251, v237
    v_mfma_f32_16x16x32_bf16 v[16:19], a[112:115], v[160:163], 0
    v_mul_f32_e32 v238, v251, v238
    v_mul_f32_e32 v239, v251, v239
    v_mfma_f32_16x16x32_bf16 v[20:23], a[116:119], v[160:163], 0
    v_mul_f32_e32 v252, v251, v252
    v_mul_f32_e32 v253, v251, v253
    v_mfma_f32_16x16x32_bf16 v[24:27], a[120:123], v[160:163], 0
    v_cvt_pk_bf16_f32 v100, v234, v235
    v_cvt_pk_bf16_f32 v101, v236, v237
    v_mfma_f32_16x16x32_bf16 v[28:31], a[124:127], v[160:163], 0
    v_cvt_pk_bf16_f32 v102, v238, v239
    v_cvt_pk_bf16_f32 v103, v252, v253
    ds_write_b128 v229, v[100:103] offset:9216
    s_add_u32 m0, s30, 16384
    s_mov_b32 s36, 16384
    buffer_load_dwordx4 v220, s[12:15], s36 offen nt lds
    v_max3_f32 v232, v136, v137, v138
    v_max3_f32 v233, v139, v140, v141
    v_max3_f32 v232, v232, v142, v143
    v_max_f32_e32 v232, v232, v233
    v_mov_b32_e32 v233, v232
    s_nop 1
    v_permlane16_swap_b32 v232, v233
    v_max_f32_e32 v232, v232, v233
    v_mov_b32_e32 v233, v232
    s_nop 1
    v_permlane32_swap_b32 v232, v233
    v_min_f32_e64 v196, -v232, -v233
    v_mov_b32_e32 v197, v196
    v_mov_b32_e32 v198, v196
    v_mov_b32_e32 v199, v196
    s_waitcnt vmcnt(7)
    v_lshlrev_b32_e32 v234, 16, v104
    v_and_b32_e32 v235, 0xffff0000, v104
    v_lshlrev_b32_e32 v236, 16, v105
    v_and_b32_e32 v237, 0xffff0000, v105
    v_lshlrev_b32_e32 v238, 16, v106
    v_and_b32_e32 v239, 0xffff0000, v106
    v_lshlrev_b32_e32 v252, 16, v107
    v_and_b32_e32 v253, 0xffff0000, v107
    v_mul_f32_e32 v234, v251, v234
    v_mul_f32_e32 v235, v251, v235
    v_mul_f32_e32 v236, v251, v236
    v_mul_f32_e32 v237, v251, v237
    v_mul_f32_e32 v238, v251, v238
    v_mul_f32_e32 v239, v251, v239
    v_mul_f32_e32 v252, v251, v252
    v_mul_f32_e32 v253, v251, v253
    v_cvt_pk_bf16_f32 v104, v234, v235
    v_cvt_pk_bf16_f32 v105, v236, v237
    v_cvt_pk_bf16_f32 v106, v238, v239
    v_cvt_pk_bf16_f32 v107, v252, v253
    ds_write_b128 v230, v[104:107] offset:10240
    s_add_u32 m0, s30, 20480
    s_mov_b32 s37, 20480
    buffer_load_dwordx4 v220, s[12:15], s37 offen nt lds
    v_add_f32_e32 v136, v196, v136
    v_exp_f32_e32 v136, v136
    v_add_f32_e32 v137, v196, v137
    v_exp_f32_e32 v137, v137
    v_add_f32_e32 v138, v196, v138
    v_exp_f32_e32 v138, v138
    v_cvt_pk_bf16_f32 v164, v136, v137
    v_add_f32_e32 v139, v196, v139
    v_exp_f32_e32 v139, v139
    v_add_f32_e32 v140, v196, v140
    v_exp_f32_e32 v140, v140
    v_cvt_pk_bf16_f32 v165, v138, v139
    v_add_f32_e32 v141, v196, v141
    v_exp_f32_e32 v141, v141
    v_add_f32_e32 v142, v196, v142
    v_exp_f32_e32 v142, v142
    v_cvt_pk_bf16_f32 v166, v140, v141
    v_add_f32_e32 v143, v196, v143
    v_exp_f32_e32 v143, v143
    s_nop 0
    v_cvt_pk_bf16_f32 v167, v142, v143
    s_waitcnt vmcnt(7)
    v_mfma_f32_16x16x32_bf16 v[136:139], a[128:131], a[16:19], v[196:199]
    v_lshlrev_b32_e32 v234, 16, v108
    v_and_b32_e32 v235, 0xffff0000, v108
    v_lshlrev_b32_e32 v236, 16, v109
    v_mfma_f32_16x16x32_bf16 v[136:139], a[132:135], a[20:23], v[136:139]
    v_and_b32_e32 v237, 0xffff0000, v109
    v_lshlrev_b32_e32 v238, 16, v110
    v_and_b32_e32 v239, 0xffff0000, v110
    v_mfma_f32_16x16x32_bf16 v[136:139], a[136:139], a[24:27], v[136:139]
    v_lshlrev_b32_e32 v252, 16, v111
    v_and_b32_e32 v253, 0xffff0000, v111
    v_mul_f32_e32 v234, v251, v234
    v_mfma_f32_16x16x32_bf16 v[136:139], a[140:143], a[28:31], v[136:139]
    v_mul_f32_e32 v235, v251, v235
    v_mul_f32_e32 v236, v251, v236
    v_mul_f32_e32 v237, v251, v237
    v_mfma_f32_16x16x32_bf16 v[140:143], a[144:147], a[16:19], v[196:199]
    v_mul_f32_e32 v238, v251, v238
    v_mul_f32_e32 v239, v251, v239
    v_mfma_f32_16x16x32_bf16 v[140:143], a[148:151], a[20:23], v[140:143]
    v_mul_f32_e32 v252, v251, v252
    v_mul_f32_e32 v253, v251, v253
    v_mfma_f32_16x16x32_bf16 v[140:143], a[152:155], a[24:27], v[140:143]
    v_cvt_pk_bf16_f32 v108, v234, v235
    v_cvt_pk_bf16_f32 v109, v236, v237
    v_mfma_f32_16x16x32_bf16 v[140:143], a[156:159], a[28:31], v[140:143]
    v_cvt_pk_bf16_f32 v110, v238, v239
    v_cvt_pk_bf16_f32 v111, v252, v253
    ds_write_b128 v231, v[108:111] offset:11264
    ds_read_b128 a[32:35], v244 offset:8192
    ds_read_b128 a[36:39], v245 offset:8192
    ds_read_b128 a[40:43], v246 offset:8192
    ds_read_b128 a[44:47], v247 offset:8192
    s_add_u32 m0, s30, 57344
    s_mov_b32 s38, 8192
    buffer_load_dwordx4 v221, s[20:23], s38 offen nt lds
    s_waitcnt vmcnt(7)
    s_waitcnt lgkmcnt(0)
    v_mfma_f32_16x16x32_bf16 v[144:147], a[64:67], a[32:35], 0
    v_lshlrev_b32_e32 v234, 16, v112
    v_and_b32_e32 v235, 0xffff0000, v112
    v_lshlrev_b32_e32 v236, 16, v113
    v_mfma_f32_16x16x32_bf16 v[144:147], a[68:71], a[36:39], v[144:147]
    v_and_b32_e32 v237, 0xffff0000, v113
    v_lshlrev_b32_e32 v238, 16, v114
    v_and_b32_e32 v239, 0xffff0000, v114
    v_mfma_f32_16x16x32_bf16 v[144:147], a[72:75], a[40:43], v[144:147]
    v_lshlrev_b32_e32 v252, 16, v115
    v_and_b32_e32 v253, 0xffff0000, v115
    v_mul_f32_e32 v234, v251, v234
    v_mfma_f32_16x16x32_bf16 v[144:147], a[76:79], a[44:47], v[144:147]
    v_mul_f32_e32 v235, v251, v235
    v_mul_f32_e32 v236, v251, v236
    v_mul_f32_e32 v237, v251, v237
    v_mfma_f32_16x16x32_bf16 v[148:151], a[80:83], a[32:35], 0
    v_mul_f32_e32 v238, v251, v238
    v_mul_f32_e32 v239, v251, v239
    v_mfma_f32_16x16x32_bf16 v[148:151], a[84:87], a[36:39], v[148:151]
    v_mul_f32_e32 v252, v251, v252
    v_mul_f32_e32 v253, v251, v253
    v_mfma_f32_16x16x32_bf16 v[148:151], a[88:91], a[40:43], v[148:151]
    v_cvt_pk_bf16_f32 v112, v234, v235
    v_cvt_pk_bf16_f32 v113, v236, v237
    v_mfma_f32_16x16x32_bf16 v[148:151], a[92:95], a[44:47], v[148:151]
    v_cvt_pk_bf16_f32 v114, v238, v239
    v_cvt_pk_bf16_f32 v115, v252, v253
    ds_write_b128 v228, v[112:115] offset:12288
    s_add_u32 m0, s30, 61440
    s_mov_b32 s39, 12288
    buffer_load_dwordx4 v221, s[20:23], s39 offen nt lds
    v_exp_f32_e32 v136, v136
    v_exp_f32_e32 v137, v137
    v_exp_f32_e32 v138, v138
    v_cvt_pk_bf16_f32 v180, v136, v137
    v_exp_f32_e32 v139, v139
    v_exp_f32_e32 v140, v140
    v_cvt_pk_bf16_f32 v181, v138, v139
    v_exp_f32_e32 v141, v141
    v_exp_f32_e32 v142, v142
    v_cvt_pk_bf16_f32 v182, v140, v141
    v_exp_f32_e32 v143, v143
    s_nop 0
    v_cvt_pk_bf16_f32 v183, v142, v143
    s_waitcnt vmcnt(7)
    v_mfma_f32_16x16x32_bf16 a[228:231], a[240:243], v[164:167], 0
    v_lshlrev_b32_e32 v234, 16, v116
    v_and_b32_e32 v235, 0xffff0000, v116
    v_lshlrev_b32_e32 v236, 16, v117
    v_mfma_f32_16x16x32_bf16 v[32:35], a[96:99], v[164:167], 0
    v_and_b32_e32 v237, 0xffff0000, v117
    v_lshlrev_b32_e32 v238, 16, v118
    v_and_b32_e32 v239, 0xffff0000, v118
    v_mfma_f32_16x16x32_bf16 v[36:39], a[100:103], v[164:167], 0
    v_lshlrev_b32_e32 v252, 16, v119
    v_and_b32_e32 v253, 0xffff0000, v119
    v_mfma_f32_16x16x32_bf16 v[40:43], a[104:107], v[164:167], 0
    v_mul_f32_e32 v234, v251, v234
    v_mul_f32_e32 v235, v251, v235
    v_mfma_f32_16x16x32_bf16 v[44:47], a[108:111], v[164:167], 0
    v_mul_f32_e32 v236, v251, v236
    v_mul_f32_e32 v237, v251, v237
    v_mfma_f32_16x16x32_bf16 v[48:51], a[112:115], v[164:167], 0
    v_mul_f32_e32 v238, v251, v238
    v_mul_f32_e32 v239, v251, v239
    v_mfma_f32_16x16x32_bf16 v[52:55], a[116:119], v[164:167], 0
    v_mul_f32_e32 v252, v251, v252
    v_mul_f32_e32 v253, v251, v253
    v_mfma_f32_16x16x32_bf16 v[56:59], a[120:123], v[164:167], 0
    v_cvt_pk_bf16_f32 v116, v234, v235
    v_cvt_pk_bf16_f32 v117, v236, v237
    v_mfma_f32_16x16x32_bf16 v[60:63], a[124:127], v[164:167], 0
    v_cvt_pk_bf16_f32 v118, v238, v239
    v_cvt_pk_bf16_f32 v119, v252, v253
    ds_write_b128 v229, v[116:119] offset:13312
    s_add_u32 m0, s30, 24576
    s_mov_b32 s36, 24576
    buffer_load_dwordx4 v220, s[12:15], s36 offen nt lds
    v_max3_f32 v232, v144, v145, v146
    v_max3_f32 v233, v147, v148, v149
    v_max3_f32 v232, v232, v150, v151
    v_max_f32_e32 v232, v232, v233
    v_mov_b32_e32 v233, v232
    s_nop 1
    v_permlane16_swap_b32 v232, v233
    v_max_f32_e32 v232, v232, v233
    v_mov_b32_e32 v233, v232
    s_nop 1
    v_permlane32_swap_b32 v232, v233
    v_min_f32_e64 v200, -v232, -v233
    v_mov_b32_e32 v201, v200
    v_mov_b32_e32 v202, v200
    v_mov_b32_e32 v203, v200
    s_waitcnt vmcnt(7)
    v_lshlrev_b32_e32 v234, 16, v120
    v_and_b32_e32 v235, 0xffff0000, v120
    v_lshlrev_b32_e32 v236, 16, v121
    v_and_b32_e32 v237, 0xffff0000, v121
    v_lshlrev_b32_e32 v238, 16, v122
    v_and_b32_e32 v239, 0xffff0000, v122
    v_lshlrev_b32_e32 v252, 16, v123
    v_and_b32_e32 v253, 0xffff0000, v123
    v_mul_f32_e32 v234, v251, v234
    v_mul_f32_e32 v235, v251, v235
    v_mul_f32_e32 v236, v251, v236
    v_mul_f32_e32 v237, v251, v237
    v_mul_f32_e32 v238, v251, v238
    v_mul_f32_e32 v239, v251, v239
    v_mul_f32_e32 v252, v251, v252
    v_mul_f32_e32 v253, v251, v253
    v_cvt_pk_bf16_f32 v120, v234, v235
    v_cvt_pk_bf16_f32 v121, v236, v237
    v_cvt_pk_bf16_f32 v122, v238, v239
    v_cvt_pk_bf16_f32 v123, v252, v253
    ds_write_b128 v230, v[120:123] offset:14336
    s_add_u32 m0, s30, 28672
    s_mov_b32 s37, 28672
    buffer_load_dwordx4 v220, s[12:15], s37 offen nt lds
    v_add_f32_e32 v144, v200, v144
    v_exp_f32_e32 v144, v144
    v_add_f32_e32 v145, v200, v145
    v_exp_f32_e32 v145, v145
    v_add_f32_e32 v146, v200, v146
    v_exp_f32_e32 v146, v146
    v_cvt_pk_bf16_f32 v168, v144, v145
    v_add_f32_e32 v147, v200, v147
    v_exp_f32_e32 v147, v147
    v_add_f32_e32 v148, v200, v148
    v_exp_f32_e32 v148, v148
    v_cvt_pk_bf16_f32 v169, v146, v147
    v_add_f32_e32 v149, v200, v149
    v_exp_f32_e32 v149, v149
    v_add_f32_e32 v150, v200, v150
    v_exp_f32_e32 v150, v150
    v_cvt_pk_bf16_f32 v170, v148, v149
    v_add_f32_e32 v151, v200, v151
    v_exp_f32_e32 v151, v151
    s_nop 0
    v_cvt_pk_bf16_f32 v171, v150, v151
    s_waitcnt vmcnt(7)
    v_mfma_f32_16x16x32_bf16 v[144:147], a[128:131], a[32:35], v[200:203]
    v_lshlrev_b32_e32 v234, 16, v124
    v_and_b32_e32 v235, 0xffff0000, v124
    v_lshlrev_b32_e32 v236, 16, v125
    v_mfma_f32_16x16x32_bf16 v[144:147], a[132:135], a[36:39], v[144:147]
    v_and_b32_e32 v237, 0xffff0000, v125
    v_lshlrev_b32_e32 v238, 16, v126
    v_and_b32_e32 v239, 0xffff0000, v126
    v_mfma_f32_16x16x32_bf16 v[144:147], a[136:139], a[40:43], v[144:147]
    v_lshlrev_b32_e32 v252, 16, v127
    v_and_b32_e32 v253, 0xffff0000, v127
    v_mul_f32_e32 v234, v251, v234
    v_mfma_f32_16x16x32_bf16 v[144:147], a[140:143], a[44:47], v[144:147]
    v_mul_f32_e32 v235, v251, v235
    v_mul_f32_e32 v236, v251, v236
    v_mul_f32_e32 v237, v251, v237
    v_mfma_f32_16x16x32_bf16 v[148:151], a[144:147], a[32:35], v[200:203]
    v_mul_f32_e32 v238, v251, v238
    v_mul_f32_e32 v239, v251, v239
    v_mfma_f32_16x16x32_bf16 v[148:151], a[148:151], a[36:39], v[148:151]
    v_mul_f32_e32 v252, v251, v252
    v_mul_f32_e32 v253, v251, v253
    v_mfma_f32_16x16x32_bf16 v[148:151], a[152:155], a[40:43], v[148:151]
    v_cvt_pk_bf16_f32 v124, v234, v235
    v_cvt_pk_bf16_f32 v125, v236, v237
    v_mfma_f32_16x16x32_bf16 v[148:151], a[156:159], a[44:47], v[148:151]
    v_cvt_pk_bf16_f32 v126, v238, v239
    v_cvt_pk_bf16_f32 v127, v252, v253
    ds_write_b128 v231, v[124:127] offset:15360
    ds_read_b128 a[48:51], v244 offset:12288
    ds_read_b128 a[52:55], v245 offset:12288
    ds_read_b128 a[56:59], v246 offset:12288
    ds_read_b128 a[60:63], v247 offset:12288
    v_mfma_f32_16x16x32_bf16 a[232:235], a[240:243], v[168:171], 0
    v_exp_f32_e32 v144, v144
    v_mfma_f32_16x16x32_bf16 v[64:67], a[96:99], v[168:171], 0
    v_exp_f32_e32 v145, v145
    v_mfma_f32_16x16x32_bf16 v[68:71], a[100:103], v[168:171], 0
    v_exp_f32_e32 v146, v146
    v_mfma_f32_16x16x32_bf16 v[72:75], a[104:107], v[168:171], 0
    v_cvt_pk_bf16_f32 v184, v144, v145
    v_mfma_f32_16x16x32_bf16 v[76:79], a[108:111], v[168:171], 0
    v_exp_f32_e32 v147, v147
    v_mfma_f32_16x16x32_bf16 v[80:83], a[112:115], v[168:171], 0
    s_waitcnt lgkmcnt(0)
    v_exp_f32_e32 v148, v148
    v_mfma_f32_16x16x32_bf16 v[84:87], a[116:119], v[168:171], 0
    v_cvt_pk_bf16_f32 v185, v146, v147
    v_mfma_f32_16x16x32_bf16 v[88:91], a[120:123], v[168:171], 0
    v_exp_f32_e32 v149, v149
    v_mfma_f32_16x16x32_bf16 v[92:95], a[124:127], v[168:171], 0
    s_waitcnt vmcnt(4)
    v_exp_f32_e32 v150, v150
    v_mfma_f32_16x16x32_bf16 v[152:155], a[64:67], a[48:51], 0
    v_cvt_pk_bf16_f32 v186, v148, v149
    v_mfma_f32_16x16x32_bf16 v[152:155], a[68:71], a[52:55], v[152:155]
    s_barrier
    ds_read_b128 a[192:195], v208 offset:16384
    ds_read_b128 a[196:199], v209 offset:16384
    ds_read_b128 a[200:203], v210 offset:16384
    ds_read_b128 a[204:207], v211 offset:16384
    v_mfma_f32_16x16x32_bf16 v[152:155], a[72:75], a[56:59], v[152:155]
    ds_read_b128 a[208:211], v208 offset:20480
    ds_read_b128 a[212:215], v209 offset:20480
    ds_read_b128 a[216:219], v210 offset:20480
    ds_read_b128 a[220:223], v211 offset:20480
    v_exp_f32_e32 v151, v151
    v_mfma_f32_16x16x32_bf16 v[152:155], a[76:79], a[60:63], v[152:155]
    s_mov_b32 s38, 16384
    v_cvt_pk_bf16_f32 v187, v150, v151
    v_mfma_f32_16x16x32_bf16 v[156:159], a[80:83], a[48:51], 0
    s_waitcnt lgkmcnt(7)
    v_mfma_f32_16x16x32_bf16 v[156:159], a[84:87], a[52:55], v[156:159]
    s_waitcnt lgkmcnt(6)
    v_mfma_f32_16x16x32_bf16 v[156:159], a[88:91], a[56:59], v[156:159]
    s_waitcnt lgkmcnt(5)
    v_mfma_f32_16x16x32_bf16 v[156:159], a[92:95], a[60:63], v[156:159]
    s_waitcnt lgkmcnt(4)
    v_mfma_f32_16x16x32_bf16 v[128:131], a[192:195], a[0:3], v[192:195]
    s_waitcnt lgkmcnt(0)
    v_mfma_f32_16x16x32_bf16 v[128:131], a[196:199], a[4:7], v[128:131]
    s_add_u32 m0, s30, 65536
    v_mfma_f32_16x16x32_bf16 v[128:131], a[200:203], a[8:11], v[128:131]
    buffer_load_dwordx4 v221, s[20:23], s38 offen nt lds
    v_mfma_f32_16x16x32_bf16 v[128:131], a[204:207], a[12:15], v[128:131]
    s_mov_b32 s39, 20480
    v_max3_f32 v232, v152, v153, v154
    v_max3_f32 v233, v155, v156, v157
    v_max3_f32 v232, v232, v158, v159
    v_mfma_f32_16x16x32_bf16 v[132:135], a[208:211], a[0:3], v[192:195]
    s_add_u32 m0, s30, 69632
    v_max_f32_e32 v232, v232, v233
    v_mov_b32_e32 v233, v232
    s_nop 1
    v_mfma_f32_16x16x32_bf16 v[132:135], a[212:215], a[4:7], v[132:135]
    v_permlane16_swap_b32 v232, v233
    v_max_f32_e32 v232, v232, v233
    v_mov_b32_e32 v233, v232
    v_mfma_f32_16x16x32_bf16 v[132:135], a[216:219], a[8:11], v[132:135]
    s_nop 1
    v_permlane32_swap_b32 v232, v233
    v_min_f32_e64 v204, -v232, -v233
    v_mfma_f32_16x16x32_bf16 v[132:135], a[220:223], a[12:15], v[132:135]
    v_mov_b32_e32 v205, v204
    v_mov_b32_e32 v206, v204
    v_mov_b32_e32 v207, v204
    v_mfma_f32_16x16x32_bf16 v[136:139], a[192:195], a[16:19], v[196:199]
    v_add_f32_e32 v152, v204, v152
    v_exp_f32_e32 v152, v152
    v_mfma_f32_16x16x32_bf16 v[136:139], a[196:199], a[20:23], v[136:139]
    v_add_f32_e32 v153, v204, v153
    v_exp_f32_e32 v153, v153
    v_mfma_f32_16x16x32_bf16 v[136:139], a[200:203], a[24:27], v[136:139]
    buffer_load_dwordx4 v221, s[20:23], s39 offen nt lds
    v_add_f32_e32 v154, v204, v154
    v_mfma_f32_16x16x32_bf16 v[136:139], a[204:207], a[28:31], v[136:139]
    s_mov_b32 s36, 32768
    v_exp_f32_e32 v154, v154
    v_cvt_pk_bf16_f32 v172, v152, v153
    v_mfma_f32_16x16x32_bf16 v[140:143], a[208:211], a[16:19], v[196:199]
    s_add_u32 m0, s30, 32768
    v_add_f32_e32 v155, v204, v155
    v_exp_f32_e32 v155, v155
    v_mfma_f32_16x16x32_bf16 v[140:143], a[212:215], a[20:23], v[140:143]
    buffer_load_dwordx4 v220, s[12:15], s36 offen nt lds
    v_add_f32_e32 v156, v204, v156
    v_mfma_f32_16x16x32_bf16 v[140:143], a[216:219], a[24:27], v[140:143]
    s_mov_b32 s37, 36864
    v_exp_f32_e32 v156, v156
    v_cvt_pk_bf16_f32 v173, v154, v155
    v_mfma_f32_16x16x32_bf16 v[140:143], a[220:223], a[28:31], v[140:143]
    s_add_u32 m0, s30, 36864
    v_add_f32_e32 v157, v204, v157
    v_exp_f32_e32 v157, v157
    v_mfma_f32_16x16x32_bf16 v[144:147], a[192:195], a[32:35], v[200:203]
    buffer_load_dwordx4 v220, s[12:15], s37 offen nt lds
    v_add_f32_e32 v158, v204, v158
    v_mfma_f32_16x16x32_bf16 v[144:147], a[196:199], a[36:39], v[144:147]
    s_mov_b32 s38, 24576
    v_exp_f32_e32 v158, v158
    v_cvt_pk_bf16_f32 v174, v156, v157
    v_mfma_f32_16x16x32_bf16 v[144:147], a[200:203], a[40:43], v[144:147]
    s_add_u32 m0, s30, 73728
    v_add_f32_e32 v159, v204, v159
    v_exp_f32_e32 v159, v159
    v_mfma_f32_16x16x32_bf16 v[144:147], a[204:207], a[44:47], v[144:147]
    v_exp_f32_e32 v128, v128
    v_mfma_f32_16x16x32_bf16 v[148:151], a[208:211], a[32:35], v[200:203]
    v_cvt_pk_bf16_f32 v175, v158, v159
    v_exp_f32_e32 v129, v129
    v_mfma_f32_16x16x32_bf16 v[148:151], a[212:215], a[36:39], v[148:151]
    v_exp_f32_e32 v130, v130
    v_mfma_f32_16x16x32_bf16 v[148:151], a[216:219], a[40:43], v[148:151]
    v_cvt_pk_bf16_f32 v160, v128, v129
    v_mfma_f32_16x16x32_bf16 v[148:151], a[220:223], a[44:47], v[148:151]
    v_exp_f32_e32 v131, v131
    v_mfma_f32_16x16x32_bf16 v[152:155], a[128:131], a[48:51], v[204:207]
    v_exp_f32_e32 v132, v132
    v_mfma_f32_16x16x32_bf16 v[152:155], a[132:135], a[52:55], v[152:155]
    v_cvt_pk_bf16_f32 v161, v130, v131
    v_mfma_f32_16x16x32_bf16 v[152:155], a[136:139], a[56:59], v[152:155]
    v_exp_f32_e32 v133, v133
    v_mfma_f32_16x16x32_bf16 v[152:155], a[140:143], a[60:63], v[152:155]
    buffer_load_dwordx4 v221, s[20:23], s38 offen nt lds
    v_mfma_f32_16x16x32_bf16 v[156:159], a[144:147], a[48:51], v[204:207]
    s_mov_b32 s39, 28672
    v_exp_f32_e32 v134, v134
    v_mfma_f32_16x16x32_bf16 v[156:159], a[148:151], a[52:55], v[156:159]
    s_add_u32 m0, s30, 77824
    v_cvt_pk_bf16_f32 v162, v132, v133
    v_exp_f32_e32 v135, v135
    v_mfma_f32_16x16x32_bf16 v[156:159], a[152:155], a[56:59], v[156:159]
    v_mfma_f32_16x16x32_bf16 v[156:159], a[156:159], a[60:63], v[156:159]
    v_exp_f32_e32 v152, v152
    v_mfma_f32_16x16x32_bf16 a[236:239], a[240:243], v[172:175], 0
    v_cvt_pk_bf16_f32 v163, v134, v135
    v_exp_f32_e32 v153, v153
    v_mfma_f32_16x16x32_bf16 v[96:99], a[96:99], v[172:175], 0
    v_exp_f32_e32 v154, v154
    v_mfma_f32_16x16x32_bf16 v[100:103], a[100:103], v[172:175], 0
    v_cvt_pk_bf16_f32 v188, v152, v153
    v_mfma_f32_16x16x32_bf16 v[104:107], a[104:107], v[172:175], 0
    v_exp_f32_e32 v155, v155
    v_mfma_f32_16x16x32_bf16 v[108:111], a[108:111], v[172:175], 0
    s_waitcnt vmcnt(7)
    v_exp_f32_e32 v156, v156
    v_mfma_f32_16x16x32_bf16 v[112:115], a[112:115], v[172:175], 0
    v_cvt_pk_bf16_f32 v189, v154, v155
    v_mfma_f32_16x16x32_bf16 v[116:119], a[116:119], v[172:175], 0
    s_barrier
    ds_read_b64_tr_b16 a[160:161], v212 offset:8192
    ds_read_b64_tr_b16 a[162:163], v212 offset:12288
    ds_read_b64_tr_b16 a[164:165], v213 offset:8192
    ds_read_b64_tr_b16 a[166:167], v213 offset:12288
    v_mfma_f32_16x16x32_bf16 v[120:123], a[120:123], v[172:175], 0
    ds_read_b64_tr_b16 a[168:169], v214 offset:8192
    ds_read_b64_tr_b16 a[170:171], v214 offset:12288
    ds_read_b64_tr_b16 a[172:173], v215 offset:8192
    ds_read_b64_tr_b16 a[174:175], v215 offset:12288
    v_exp_f32_e32 v157, v157
    v_mfma_f32_16x16x32_bf16 v[124:127], a[124:127], v[172:175], 0
    ds_read_b64_tr_b16 a[176:177], v216 offset:8192
    ds_read_b64_tr_b16 a[178:179], v216 offset:12288
    ds_read_b64_tr_b16 a[180:181], v217 offset:8192
    ds_read_b64_tr_b16 a[182:183], v217 offset:12288
    v_mfma_f32_16x16x32_bf16 a[224:227], a[240:243], v[176:179], a[224:227]
    ds_read_b64_tr_b16 a[184:185], v218 offset:8192
    ds_read_b64_tr_b16 a[186:187], v218 offset:12288
    ds_read_b64_tr_b16 a[188:189], v219 offset:8192
    ds_read_b64_tr_b16 a[190:191], v219 offset:12288
    v_exp_f32_e32 v158, v158
    v_cvt_pk_bf16_f32 v190, v156, v157
    s_waitcnt lgkmcnt(14)
    v_mfma_f32_16x16x32_bf16 v[0:3], a[160:163], v[176:179], v[0:3]
    s_waitcnt lgkmcnt(6)
    v_exp_f32_e32 v159, v159
    v_mfma_f32_16x16x32_bf16 v[4:7], a[164:167], v[176:179], v[4:7]
    buffer_load_dwordx4 v221, s[20:23], s39 offen nt lds
    v_exp_f32_e32 v136, v136
    v_mfma_f32_16x16x32_bf16 v[8:11], a[168:171], v[176:179], v[8:11]
    s_waitcnt lgkmcnt(2)
    v_cvt_pk_bf16_f32 v191, v158, v159
    v_exp_f32_e32 v137, v137
    v_mfma_f32_16x16x32_bf16 v[12:15], a[172:175], v[176:179], v[12:15]
    s_waitcnt lgkmcnt(0)
    v_exp_f32_e32 v138, v138
    v_mfma_f32_16x16x32_bf16 v[16:19], a[176:179], v[176:179], v[16:19]
    v_cvt_pk_bf16_f32 v164, v136, v137
    v_mfma_f32_16x16x32_bf16 v[20:23], a[180:183], v[176:179], v[20:23]
    v_exp_f32_e32 v139, v139
    v_mfma_f32_16x16x32_bf16 v[24:27], a[184:187], v[176:179], v[24:27]
    v_exp_f32_e32 v140, v140
    v_mfma_f32_16x16x32_bf16 v[28:31], a[188:191], v[176:179], v[28:31]
    v_cvt_pk_bf16_f32 v165, v138, v139
    v_mfma_f32_16x16x32_bf16 v[152:155], a[192:195], a[48:51], v[204:207]
    v_exp_f32_e32 v141, v141
    v_mfma_f32_16x16x32_bf16 v[152:155], a[196:199], a[52:55], v[152:155]
    v_exp_f32_e32 v142, v142
    v_mfma_f32_16x16x32_bf16 v[152:155], a[200:203], a[56:59], v[152:155]
    v_cvt_pk_bf16_f32 v166, v140, v141
    v_mfma_f32_16x16x32_bf16 v[152:155], a[204:207], a[60:63], v[152:155]
    v_exp_f32_e32 v143, v143
    v_mfma_f32_16x16x32_bf16 v[156:159], a[208:211], a[48:51], v[204:207]
    v_exp_f32_e32 v144, v144
    v_mfma_f32_16x16x32_bf16 v[156:159], a[212:215], a[52:55], v[156:159]
    v_cvt_pk_bf16_f32 v167, v142, v143
    v_mfma_f32_16x16x32_bf16 v[156:159], a[216:219], a[56:59], v[156:159]
    v_exp_f32_e32 v145, v145
    v_mfma_f32_16x16x32_bf16 v[156:159], a[220:223], a[60:63], v[156:159]
    v_exp_f32_e32 v146, v146
    v_mfma_f32_16x16x32_bf16 a[228:231], a[240:243], v[180:183], a[228:231]
    v_cvt_pk_bf16_f32 v168, v144, v145
    v_mfma_f32_16x16x32_bf16 v[32:35], a[160:163], v[180:183], v[32:35]
    v_exp_f32_e32 v147, v147
    v_mfma_f32_16x16x32_bf16 v[36:39], a[164:167], v[180:183], v[36:39]
    v_exp_f32_e32 v148, v148
    v_mfma_f32_16x16x32_bf16 v[40:43], a[168:171], v[180:183], v[40:43]
    v_cvt_pk_bf16_f32 v169, v146, v147
    v_mfma_f32_16x16x32_bf16 v[44:47], a[172:175], v[180:183], v[44:47]
    v_exp_f32_e32 v149, v149
    v_mfma_f32_16x16x32_bf16 v[48:51], a[176:179], v[180:183], v[48:51]
    v_exp_f32_e32 v150, v150
    v_mfma_f32_16x16x32_bf16 v[52:55], a[180:183], v[180:183], v[52:55]
    v_cvt_pk_bf16_f32 v170, v148, v149
    v_mfma_f32_16x16x32_bf16 v[56:59], a[184:187], v[180:183], v[56:59]
    v_exp_f32_e32 v151, v151
    v_mfma_f32_16x16x32_bf16 v[60:63], a[188:191], v[180:183], v[60:63]
    v_exp_f32_e32 v152, v152
    v_mfma_f32_16x16x32_bf16 a[232:235], a[240:243], v[184:187], a[232:235]
    v_cvt_pk_bf16_f32 v171, v150, v151
    v_mfma_f32_16x16x32_bf16 v[64:67], a[160:163], v[184:187], v[64:67]
    v_exp_f32_e32 v153, v153
    v_mfma_f32_16x16x32_bf16 v[68:71], a[164:167], v[184:187], v[68:71]
    v_exp_f32_e32 v154, v154
    v_mfma_f32_16x16x32_bf16 v[72:75], a[168:171], v[184:187], v[72:75]
    v_cvt_pk_bf16_f32 v172, v152, v153
    v_mfma_f32_16x16x32_bf16 v[76:79], a[172:175], v[184:187], v[76:79]
    v_exp_f32_e32 v155, v155
    v_mfma_f32_16x16x32_bf16 v[80:83], a[176:179], v[184:187], v[80:83]
    v_exp_f32_e32 v156, v156
    v_mfma_f32_16x16x32_bf16 v[84:87], a[180:183], v[184:187], v[84:87]
    v_cvt_pk_bf16_f32 v173, v154, v155
    v_mfma_f32_16x16x32_bf16 v[88:91], a[184:187], v[184:187], v[88:91]
    v_exp_f32_e32 v157, v157
    v_mfma_f32_16x16x32_bf16 v[92:95], a[188:191], v[184:187], v[92:95]
    v_exp_f32_e32 v158, v158
    v_mfma_f32_16x16x32_bf16 a[236:239], a[240:243], v[188:191], a[236:239]
    v_cvt_pk_bf16_f32 v174, v156, v157
    v_mfma_f32_16x16x32_bf16 v[96:99], a[160:163], v[188:191], v[96:99]
    v_exp_f32_e32 v159, v159
    v_mfma_f32_16x16x32_bf16 v[100:103], a[164:167], v[188:191], v[100:103]
    v_mfma_f32_16x16x32_bf16 v[104:107], a[168:171], v[188:191], v[104:107]
    s_waitcnt vmcnt(6)
    v_mfma_f32_16x16x32_bf16 v[108:111], a[172:175], v[188:191], v[108:111]
    v_mfma_f32_16x16x32_bf16 v[112:115], a[176:179], v[188:191], v[112:115]
    s_barrier
    v_mfma_f32_16x16x32_bf16 v[116:119], a[180:183], v[188:191], v[116:119]
    ds_read_b128 a[128:131], v208 offset:24576
    ds_read_b128 a[132:135], v209 offset:24576
    ds_read_b128 a[136:139], v210 offset:24576
    ds_read_b128 a[140:143], v211 offset:24576
    v_mfma_f32_16x16x32_bf16 v[120:123], a[184:187], v[188:191], v[120:123]
    ds_read_b128 a[144:147], v208 offset:28672
    ds_read_b128 a[148:151], v209 offset:28672
    ds_read_b128 a[152:155], v210 offset:28672
    ds_read_b128 a[156:159], v211 offset:28672
    v_mfma_f32_16x16x32_bf16 v[124:127], a[188:191], v[188:191], v[124:127]
    s_waitcnt lgkmcnt(4)
    v_mfma_f32_16x16x32_bf16 v[128:131], a[128:131], a[0:3], v[192:195]
    s_waitcnt lgkmcnt(3)
    v_mfma_f32_16x16x32_bf16 v[128:131], a[132:135], a[4:7], v[128:131]
    s_waitcnt lgkmcnt(2)
    v_mfma_f32_16x16x32_bf16 v[128:131], a[136:139], a[8:11], v[128:131]
    s_waitcnt lgkmcnt(1)
    v_mfma_f32_16x16x32_bf16 v[128:131], a[140:143], a[12:15], v[128:131]
    s_waitcnt lgkmcnt(0)
    v_mfma_f32_16x16x32_bf16 v[132:135], a[144:147], a[0:3], v[192:195]
    v_mfma_f32_16x16x32_bf16 v[132:135], a[148:151], a[4:7], v[132:135]
    v_mfma_f32_16x16x32_bf16 v[132:135], a[152:155], a[8:11], v[132:135]
    v_mfma_f32_16x16x32_bf16 v[132:135], a[156:159], a[12:15], v[132:135]
    s_nop 2
    v_exp_f32_e32 v128, v128
    v_mfma_f32_16x16x32_bf16 v[136:139], a[128:131], a[16:19], v[196:199]
    v_cvt_pk_bf16_f32 v175, v158, v159
    v_mfma_f32_16x16x32_bf16 v[136:139], a[132:135], a[20:23], v[136:139]
    v_exp_f32_e32 v129, v129
    v_mfma_f32_16x16x32_bf16 v[136:139], a[136:139], a[24:27], v[136:139]
    v_exp_f32_e32 v130, v130
    v_mfma_f32_16x16x32_bf16 v[136:139], a[140:143], a[28:31], v[136:139]
    v_cvt_pk_bf16_f32 v176, v128, v129
    v_mfma_f32_16x16x32_bf16 v[140:143], a[144:147], a[16:19], v[196:199]
    v_exp_f32_e32 v131, v131
    v_mfma_f32_16x16x32_bf16 v[140:143], a[148:151], a[20:23], v[140:143]
    v_mfma_f32_16x16x32_bf16 v[140:143], a[152:155], a[24:27], v[140:143]
    v_exp_f32_e32 v132, v132
    v_mfma_f32_16x16x32_bf16 v[140:143], a[156:159], a[28:31], v[140:143]
    v_cvt_pk_bf16_f32 v177, v130, v131
    v_mfma_f32_16x16x32_bf16 v[144:147], a[128:131], a[32:35], v[200:203]
    v_exp_f32_e32 v133, v133
    v_mfma_f32_16x16x32_bf16 v[144:147], a[132:135], a[36:39], v[144:147]
    v_mfma_f32_16x16x32_bf16 v[144:147], a[136:139], a[40:43], v[144:147]
    v_exp_f32_e32 v134, v134
    v_mfma_f32_16x16x32_bf16 v[144:147], a[140:143], a[44:47], v[144:147]
    v_cvt_pk_bf16_f32 v178, v132, v133
    v_mfma_f32_16x16x32_bf16 v[148:151], a[144:147], a[32:35], v[200:203]
    v_exp_f32_e32 v135, v135
    v_mfma_f32_16x16x32_bf16 v[148:151], a[148:151], a[36:39], v[148:151]
    v_mfma_f32_16x16x32_bf16 v[148:151], a[152:155], a[40:43], v[148:151]
    v_mfma_f32_16x16x32_bf16 v[148:151], a[156:159], a[44:47], v[148:151]
    v_exp_f32_e32 v136, v136
    v_mfma_f32_16x16x32_bf16 v[152:155], a[128:131], a[48:51], v[204:207]
    v_cvt_pk_bf16_f32 v179, v134, v135
    v_mfma_f32_16x16x32_bf16 v[152:155], a[132:135], a[52:55], v[152:155]
    v_exp_f32_e32 v137, v137
    v_mfma_f32_16x16x32_bf16 v[152:155], a[136:139], a[56:59], v[152:155]
    v_mfma_f32_16x16x32_bf16 v[152:155], a[140:143], a[60:63], v[152:155]
    s_waitcnt vmcnt(4)
    v_exp_f32_e32 v138, v138
    v_mfma_f32_16x16x32_bf16 v[156:159], a[144:147], a[48:51], v[204:207]
    v_cvt_pk_bf16_f32 v180, v136, v137
    v_mfma_f32_16x16x32_bf16 v[156:159], a[148:151], a[52:55], v[156:159]
    s_barrier
    ds_read_b64_tr_b16 a[96:97], v212 offset:16384
    ds_read_b64_tr_b16 a[98:99], v212 offset:20480
    ds_read_b64_tr_b16 a[100:101], v213 offset:16384
    ds_read_b64_tr_b16 a[102:103], v213 offset:20480
    v_mfma_f32_16x16x32_bf16 v[156:159], a[152:155], a[56:59], v[156:159]
    ds_read_b64_tr_b16 a[104:105], v214 offset:16384
    ds_read_b64_tr_b16 a[106:107], v214 offset:20480
    ds_read_b64_tr_b16 a[108:109], v215 offset:16384
    ds_read_b64_tr_b16 a[110:111], v215 offset:20480
    v_mfma_f32_16x16x32_bf16 v[156:159], a[156:159], a[60:63], v[156:159]
    ds_read_b64_tr_b16 a[112:113], v216 offset:16384
    ds_read_b64_tr_b16 a[114:115], v216 offset:20480
    ds_read_b64_tr_b16 a[116:117], v217 offset:16384
    ds_read_b64_tr_b16 a[118:119], v217 offset:20480
    v_exp_f32_e32 v139, v139
    v_mfma_f32_16x16x32_bf16 a[224:227], a[240:243], v[160:163], a[224:227]
    ds_read_b64_tr_b16 a[120:121], v218 offset:16384
    ds_read_b64_tr_b16 a[122:123], v218 offset:20480
    ds_read_b64_tr_b16 a[124:125], v219 offset:16384
    ds_read_b64_tr_b16 a[126:127], v219 offset:20480
    s_waitcnt lgkmcnt(14)
    v_mfma_f32_16x16x32_bf16 v[0:3], a[96:99], v[160:163], v[0:3]
    s_waitcnt lgkmcnt(6)
    v_exp_f32_e32 v140, v140
    v_mfma_f32_16x16x32_bf16 v[4:7], a[100:103], v[160:163], v[4:7]
    s_waitcnt lgkmcnt(4)
    v_cvt_pk_bf16_f32 v181, v138, v139
    v_exp_f32_e32 v141, v141
    v_mfma_f32_16x16x32_bf16 v[8:11], a[104:107], v[160:163], v[8:11]
    s_waitcnt lgkmcnt(2)
    v_exp_f32_e32 v142, v142
    v_mfma_f32_16x16x32_bf16 v[12:15], a[108:111], v[160:163], v[12:15]
    s_waitcnt lgkmcnt(0)
    v_cvt_pk_bf16_f32 v182, v140, v141
    v_mfma_f32_16x16x32_bf16 v[16:19], a[112:115], v[160:163], v[16:19]
    s_mov_b32 s36, 40960
    v_exp_f32_e32 v143, v143
    v_mfma_f32_16x16x32_bf16 v[20:23], a[116:119], v[160:163], v[20:23]
    s_add_u32 m0, s30, 40960
    v_lshrrev_b32_e32 v232, 5, v223
    v_mfma_f32_16x16x32_bf16 v[24:27], a[120:123], v[160:163], v[24:27]
    buffer_load_dwordx4 v220, s[12:15], s36 offen nt lds
    v_mfma_f32_16x16x32_bf16 v[28:31], a[124:127], v[160:163], v[28:31]
    s_mov_b32 s37, 45056
    v_exp_f32_e32 v144, v144
    v_mfma_f32_16x16x32_bf16 a[228:231], a[240:243], v[164:167], a[228:231]
    s_add_u32 m0, s30, 45056
    v_cvt_pk_bf16_f32 v183, v142, v143
    v_mfma_f32_16x16x32_bf16 v[32:35], a[96:99], v[164:167], v[32:35]
    buffer_load_dwordx4 v220, s[12:15], s37 offen nt lds
    v_mfma_f32_16x16x32_bf16 v[36:39], a[100:103], v[164:167], v[36:39]
    s_mov_b32 s38, 32768
    v_exp_f32_e32 v145, v145
    v_mfma_f32_16x16x32_bf16 v[40:43], a[104:107], v[164:167], v[40:43]
    s_add_u32 m0, s30, 81920
    v_and_b32_e32 v233, 7, v223
    v_mfma_f32_16x16x32_bf16 v[44:47], a[108:111], v[164:167], v[44:47]
    buffer_load_dwordx4 v221, s[20:23], s38 offen nt lds
    v_exp_f32_e32 v146, v146
    v_mfma_f32_16x16x32_bf16 v[48:51], a[112:115], v[164:167], v[48:51]
    s_mov_b32 s39, 36864
    v_cvt_pk_bf16_f32 v184, v144, v145
    v_mfma_f32_16x16x32_bf16 v[52:55], a[116:119], v[164:167], v[52:55]
    s_add_u32 m0, s30, 86016
    v_exp_f32_e32 v147, v147
    v_mfma_f32_16x16x32_bf16 v[56:59], a[120:123], v[164:167], v[56:59]
    buffer_load_dwordx4 v221, s[20:23], s39 offen nt lds
    v_mfma_f32_16x16x32_bf16 v[60:63], a[124:127], v[164:167], v[60:63]
    v_exp_f32_e32 v148, v148
    v_mfma_f32_16x16x32_bf16 a[232:235], a[240:243], v[168:171], a[232:235]
    v_cvt_pk_bf16_f32 v185, v146, v147
    v_mfma_f32_16x16x32_bf16 v[64:67], a[96:99], v[168:171], v[64:67]
    v_exp_f32_e32 v149, v149
    v_mfma_f32_16x16x32_bf16 v[68:71], a[100:103], v[168:171], v[68:71]
    v_xor_b32_e32 v232, v232, v233
    v_mfma_f32_16x16x32_bf16 v[72:75], a[104:107], v[168:171], v[72:75]
    v_exp_f32_e32 v150, v150
    v_mfma_f32_16x16x32_bf16 v[76:79], a[108:111], v[168:171], v[76:79]
    v_cvt_pk_bf16_f32 v186, v148, v149
    v_mfma_f32_16x16x32_bf16 v[80:83], a[112:115], v[168:171], v[80:83]
    v_exp_f32_e32 v151, v151
    v_mfma_f32_16x16x32_bf16 v[84:87], a[116:119], v[168:171], v[84:87]
    v_mfma_f32_16x16x32_bf16 v[88:91], a[120:123], v[168:171], v[88:91]
    v_exp_f32_e32 v152, v152
    v_mfma_f32_16x16x32_bf16 v[92:95], a[124:127], v[168:171], v[92:95]
    v_cvt_pk_bf16_f32 v187, v150, v151
    v_mfma_f32_16x16x32_bf16 a[236:239], a[240:243], v[172:175], a[236:239]
    v_exp_f32_e32 v153, v153
    v_mfma_f32_16x16x32_bf16 v[96:99], a[96:99], v[172:175], v[96:99]
    v_lshlrev_b32_e32 v232, 4, v232
    v_mfma_f32_16x16x32_bf16 v[100:103], a[100:103], v[172:175], v[100:103]
    v_exp_f32_e32 v154, v154
    v_mfma_f32_16x16x32_bf16 v[104:107], a[104:107], v[172:175], v[104:107]
    s_waitcnt vmcnt(6)
    v_cvt_pk_bf16_f32 v188, v152, v153
    v_mfma_f32_16x16x32_bf16 v[108:111], a[108:111], v[172:175], v[108:111]
    v_exp_f32_e32 v155, v155
    v_mfma_f32_16x16x32_bf16 v[112:115], a[112:115], v[172:175], v[112:115]
    s_barrier
    v_mfma_f32_16x16x32_bf16 v[116:119], a[116:119], v[172:175], v[116:119]
    ds_read_b128 a[64:67], v208 offset:32768
    ds_read_b128 a[68:71], v209 offset:32768
    ds_read_b128 a[72:75], v210 offset:32768
    ds_read_b128 a[76:79], v211 offset:32768
    v_mfma_f32_16x16x32_bf16 v[120:123], a[120:123], v[172:175], v[120:123]
    ds_read_b128 a[80:83], v208 offset:36864
    ds_read_b128 a[84:87], v209 offset:36864
    ds_read_b128 a[88:91], v210 offset:36864
    ds_read_b128 a[92:95], v211 offset:36864
    v_mfma_f32_16x16x32_bf16 v[124:127], a[124:127], v[172:175], v[124:127]
    s_waitcnt lgkmcnt(4)
    v_exp_f32_e32 v156, v156
    v_mfma_f32_16x16x32_bf16 v[128:131], a[64:67], a[0:3], v[192:195]
    s_waitcnt lgkmcnt(3)
    v_cvt_pk_bf16_f32 v189, v154, v155
    v_bfe_u32 v233, v223, 4, 1
    v_mfma_f32_16x16x32_bf16 v[128:131], a[68:71], a[4:7], v[128:131]
    s_waitcnt lgkmcnt(2)
    v_exp_f32_e32 v157, v157
    v_mfma_f32_16x16x32_bf16 v[128:131], a[72:75], a[8:11], v[128:131]
    s_waitcnt lgkmcnt(1)
    v_exp_f32_e32 v158, v158
    v_mfma_f32_16x16x32_bf16 v[128:131], a[76:79], a[12:15], v[128:131]
    s_waitcnt lgkmcnt(0)
    v_cvt_pk_bf16_f32 v190, v156, v157
    v_mfma_f32_16x16x32_bf16 v[132:135], a[80:83], a[0:3], v[192:195]
    v_exp_f32_e32 v159, v159
    v_mfma_f32_16x16x32_bf16 v[132:135], a[84:87], a[4:7], v[132:135]
    v_mfma_f32_16x16x32_bf16 v[132:135], a[88:91], a[8:11], v[132:135]
    v_mfma_f32_16x16x32_bf16 v[132:135], a[92:95], a[12:15], v[132:135]
    s_nop 0
    v_exp_f32_e32 v128, v128
    v_mfma_f32_16x16x32_bf16 v[136:139], a[64:67], a[16:19], v[196:199]
    v_cvt_pk_bf16_f32 v191, v158, v159
    v_lshl_add_u32 v232, v233, 3, v232
    v_mfma_f32_16x16x32_bf16 v[136:139], a[68:71], a[20:23], v[136:139]
    v_exp_f32_e32 v129, v129
    v_mfma_f32_16x16x32_bf16 v[136:139], a[72:75], a[24:27], v[136:139]
    v_exp_f32_e32 v130, v130
    v_mfma_f32_16x16x32_bf16 v[136:139], a[76:79], a[28:31], v[136:139]
    v_cvt_pk_bf16_f32 v160, v128, v129
    v_mfma_f32_16x16x32_bf16 v[140:143], a[80:83], a[16:19], v[196:199]
    v_exp_f32_e32 v131, v131
    v_mfma_f32_16x16x32_bf16 v[140:143], a[84:87], a[20:23], v[140:143]
    v_mfma_f32_16x16x32_bf16 v[140:143], a[88:91], a[24:27], v[140:143]
    v_exp_f32_e32 v132, v132
    v_mfma_f32_16x16x32_bf16 v[140:143], a[92:95], a[28:31], v[140:143]
    v_cvt_pk_bf16_f32 v161, v130, v131
    v_mfma_f32_16x16x32_bf16 v[144:147], a[64:67], a[32:35], v[200:203]
    v_and_b32_e32 v233, 15, v223
    v_mfma_f32_16x16x32_bf16 v[144:147], a[68:71], a[36:39], v[144:147]
    v_exp_f32_e32 v133, v133
    v_mfma_f32_16x16x32_bf16 v[144:147], a[72:75], a[40:43], v[144:147]
    v_exp_f32_e32 v134, v134
    v_mfma_f32_16x16x32_bf16 v[144:147], a[76:79], a[44:47], v[144:147]
    v_cvt_pk_bf16_f32 v162, v132, v133
    v_mfma_f32_16x16x32_bf16 v[148:151], a[80:83], a[32:35], v[200:203]
    v_exp_f32_e32 v135, v135
    v_mfma_f32_16x16x32_bf16 v[148:151], a[84:87], a[36:39], v[148:151]
    v_mfma_f32_16x16x32_bf16 v[148:151], a[88:91], a[40:43], v[148:151]
    v_mfma_f32_16x16x32_bf16 v[148:151], a[92:95], a[44:47], v[148:151]
    v_exp_f32_e32 v136, v136
    v_mfma_f32_16x16x32_bf16 v[152:155], a[64:67], a[48:51], v[204:207]
    v_lshl_add_u32 v232, v233, 8, v232
    v_cvt_pk_bf16_f32 v163, v134, v135
    v_mfma_f32_16x16x32_bf16 v[152:155], a[68:71], a[52:55], v[152:155]
    v_exp_f32_e32 v137, v137
    v_mfma_f32_16x16x32_bf16 v[152:155], a[72:75], a[56:59], v[152:155]
    v_mfma_f32_16x16x32_bf16 v[152:155], a[76:79], a[60:63], v[152:155]
    s_waitcnt vmcnt(4)
    v_exp_f32_e32 v138, v138
    v_mfma_f32_16x16x32_bf16 v[156:159], a[80:83], a[48:51], v[204:207]
    v_cvt_pk_bf16_f32 v164, v136, v137
    v_mfma_f32_16x16x32_bf16 v[156:159], a[84:87], a[52:55], v[156:159]
    s_barrier
    ds_read_b64_tr_b16 a[160:161], v212 offset:24576
    ds_read_b64_tr_b16 a[162:163], v212 offset:28672
    ds_read_b64_tr_b16 a[164:165], v213 offset:24576
    ds_read_b64_tr_b16 a[166:167], v213 offset:28672
    v_mfma_f32_16x16x32_bf16 v[156:159], a[88:91], a[56:59], v[156:159]
    ds_read_b64_tr_b16 a[168:169], v214 offset:24576
    ds_read_b64_tr_b16 a[170:171], v214 offset:28672
    ds_read_b64_tr_b16 a[172:173], v215 offset:24576
    ds_read_b64_tr_b16 a[174:175], v215 offset:28672
    v_mfma_f32_16x16x32_bf16 v[156:159], a[92:95], a[60:63], v[156:159]
    ds_read_b64_tr_b16 a[176:177], v216 offset:24576
    ds_read_b64_tr_b16 a[178:179], v216 offset:28672
    ds_read_b64_tr_b16 a[180:181], v217 offset:24576
    ds_read_b64_tr_b16 a[182:183], v217 offset:28672
    v_exp_f32_e32 v139, v139
    v_mfma_f32_16x16x32_bf16 a[224:227], a[240:243], v[176:179], a[224:227]
    ds_read_b64_tr_b16 a[184:185], v218 offset:24576
    ds_read_b64_tr_b16 a[186:187], v218 offset:28672
    ds_read_b64_tr_b16 a[188:189], v219 offset:24576
    ds_read_b64_tr_b16 a[190:191], v219 offset:28672
    s_waitcnt lgkmcnt(14)
    v_mfma_f32_16x16x32_bf16 v[0:3], a[160:163], v[176:179], v[0:3]
    s_waitcnt lgkmcnt(6)
    v_exp_f32_e32 v140, v140
    v_mfma_f32_16x16x32_bf16 v[4:7], a[164:167], v[176:179], v[4:7]
    s_waitcnt lgkmcnt(4)
    v_add_u32_e32 v244, s31, v232
    v_cvt_pk_bf16_f32 v165, v138, v139
    v_mfma_f32_16x16x32_bf16 v[8:11], a[168:171], v[176:179], v[8:11]
    s_waitcnt lgkmcnt(2)
    v_exp_f32_e32 v141, v141
    v_mfma_f32_16x16x32_bf16 v[12:15], a[172:175], v[176:179], v[12:15]
    s_waitcnt lgkmcnt(0)
    v_exp_f32_e32 v142, v142
    v_mfma_f32_16x16x32_bf16 v[16:19], a[176:179], v[176:179], v[16:19]
    s_mov_b32 s36, 49152
    v_cvt_pk_bf16_f32 v166, v140, v141
    v_mfma_f32_16x16x32_bf16 v[20:23], a[180:183], v[176:179], v[20:23]
    s_add_u32 m0, s30, 0
    v_exp_f32_e32 v143, v143
    v_mfma_f32_16x16x32_bf16 v[24:27], a[184:187], v[176:179], v[24:27]
    buffer_load_dwordx4 v220, s[12:15], s36 offen nt lds
    v_mfma_f32_16x16x32_bf16 v[28:31], a[188:191], v[176:179], v[28:31]
    s_mov_b32 s37, 53248
    v_xor_b32_e32 v245, 32, v244
    v_mfma_f32_16x16x32_bf16 a[228:231], a[240:243], v[180:183], a[228:231]
    s_add_u32 m0, s30, 4096
    v_exp_f32_e32 v144, v144
    v_mfma_f32_16x16x32_bf16 v[32:35], a[160:163], v[180:183], v[32:35]
    buffer_load_dwordx4 v220, s[12:15], s37 offen nt lds
    v_cvt_pk_bf16_f32 v167, v142, v143
    v_mfma_f32_16x16x32_bf16 v[36:39], a[164:167], v[180:183], v[36:39]
    s_mov_b32 s38, 40960
    v_exp_f32_e32 v145, v145
    v_mfma_f32_16x16x32_bf16 v[40:43], a[168:171], v[180:183], v[40:43]
    s_add_u32 m0, s30, 49152
    v_exp_f32_e32 v146, v146
    v_mfma_f32_16x16x32_bf16 v[44:47], a[172:175], v[180:183], v[44:47]
    buffer_load_dwordx4 v221, s[20:23], s38 offen nt lds
    v_cvt_pk_bf16_f32 v168, v144, v145
    v_mfma_f32_16x16x32_bf16 v[48:51], a[176:179], v[180:183], v[48:51]
    s_mov_b32 s39, 45056
    v_exp_f32_e32 v147, v147
    v_mfma_f32_16x16x32_bf16 v[52:55], a[180:183], v[180:183], v[52:55]
    s_add_u32 m0, s30, 53248
    v_mfma_f32_16x16x32_bf16 v[56:59], a[184:187], v[180:183], v[56:59]
    buffer_load_dwordx4 v221, s[20:23], s39 offen nt lds
    v_xor_b32_e32 v246, 64, v244
    v_mfma_f32_16x16x32_bf16 v[60:63], a[188:191], v[180:183], v[60:63]
    v_exp_f32_e32 v148, v148
    v_mfma_f32_16x16x32_bf16 a[232:235], a[240:243], v[184:187], a[232:235]
    v_cvt_pk_bf16_f32 v169, v146, v147
    v_mfma_f32_16x16x32_bf16 v[64:67], a[160:163], v[184:187], v[64:67]
    v_exp_f32_e32 v149, v149
    v_mfma_f32_16x16x32_bf16 v[68:71], a[164:167], v[184:187], v[68:71]
    v_exp_f32_e32 v150, v150
    v_mfma_f32_16x16x32_bf16 v[72:75], a[168:171], v[184:187], v[72:75]
    v_cvt_pk_bf16_f32 v170, v148, v149
    v_mfma_f32_16x16x32_bf16 v[76:79], a[172:175], v[184:187], v[76:79]
    v_exp_f32_e32 v151, v151
    v_mfma_f32_16x16x32_bf16 v[80:83], a[176:179], v[184:187], v[80:83]
    v_mfma_f32_16x16x32_bf16 v[84:87], a[180:183], v[184:187], v[84:87]
    v_xor_b32_e32 v247, 96, v244
    v_mfma_f32_16x16x32_bf16 v[88:91], a[184:187], v[184:187], v[88:91]
    v_exp_f32_e32 v152, v152
    v_mfma_f32_16x16x32_bf16 v[92:95], a[188:191], v[184:187], v[92:95]
    v_cvt_pk_bf16_f32 v171, v150, v151
    v_mfma_f32_16x16x32_bf16 a[236:239], a[240:243], v[188:191], a[236:239]
    v_exp_f32_e32 v153, v153
    v_mfma_f32_16x16x32_bf16 v[96:99], a[160:163], v[188:191], v[96:99]
    v_mfma_f32_16x16x32_bf16 v[100:103], a[164:167], v[188:191], v[100:103]
    v_exp_f32_e32 v154, v154
    v_mfma_f32_16x16x32_bf16 v[104:107], a[168:171], v[188:191], v[104:107]
    s_waitcnt vmcnt(6)
    v_cvt_pk_bf16_f32 v172, v152, v153
    v_mfma_f32_16x16x32_bf16 v[108:111], a[172:175], v[188:191], v[108:111]
    v_exp_f32_e32 v155, v155
    v_mfma_f32_16x16x32_bf16 v[112:115], a[176:179], v[188:191], v[112:115]
    s_barrier
    v_mfma_f32_16x16x32_bf16 v[116:119], a[180:183], v[188:191], v[116:119]
    ds_read_b128 a[128:131], v208 offset:40960
    ds_read_b128 a[132:135], v209 offset:40960
    ds_read_b128 a[136:139], v210 offset:40960
    ds_read_b128 a[140:143], v211 offset:40960
    v_mfma_f32_16x16x32_bf16 v[120:123], a[184:187], v[188:191], v[120:123]
    s_waitcnt vmcnt(4)
    ds_read_b128 a[144:147], v208 offset:45056
    ds_read_b128 a[148:151], v209 offset:45056
    ds_read_b128 a[152:155], v210 offset:45056
    ds_read_b128 a[156:159], v211 offset:45056
    v_mfma_f32_16x16x32_bf16 v[124:127], a[188:191], v[188:191], v[124:127]
    s_waitcnt lgkmcnt(4)
    v_exp_f32_e32 v156, v156
    v_mfma_f32_16x16x32_bf16 v[128:131], a[128:131], a[0:3], v[192:195]
    s_barrier
    ds_read_b64_tr_b16 a[96:97], v212 offset:32768
    v_cvt_pk_bf16_f32 v173, v154, v155
    v_mfma_f32_16x16x32_bf16 v[128:131], a[132:135], a[4:7], v[128:131]
    ds_read_b64_tr_b16 a[98:99], v212 offset:36864
    v_exp_f32_e32 v157, v157
    v_mfma_f32_16x16x32_bf16 v[128:131], a[136:139], a[8:11], v[128:131]
    ds_read_b64_tr_b16 a[100:101], v213 offset:32768
    ds_read_b64_tr_b16 a[102:103], v213 offset:36864
    v_mfma_f32_16x16x32_bf16 v[128:131], a[140:143], a[12:15], v[128:131]
    s_waitcnt lgkmcnt(4)
    v_exp_f32_e32 v158, v158
    v_mfma_f32_16x16x32_bf16 v[132:135], a[144:147], a[0:3], v[192:195]
    ds_read_b64_tr_b16 a[104:105], v214 offset:32768
    v_cvt_pk_bf16_f32 v174, v156, v157
    v_mfma_f32_16x16x32_bf16 v[132:135], a[148:151], a[4:7], v[132:135]
    s_mov_b32 s36, 57344
    v_exp_f32_e32 v159, v159
    v_mfma_f32_16x16x32_bf16 v[132:135], a[152:155], a[8:11], v[132:135]
    ds_read_b64_tr_b16 a[106:107], v214 offset:36864
    ds_read_b64_tr_b16 a[108:109], v215 offset:32768
    v_mfma_f32_16x16x32_bf16 v[132:135], a[156:159], a[12:15], v[132:135]
    ds_read_b64_tr_b16 a[110:111], v215 offset:36864
    ds_read_b64_tr_b16 a[112:113], v216 offset:32768
    v_mfma_f32_16x16x32_bf16 v[136:139], a[128:131], a[16:19], v[196:199]
    s_add_u32 m0, s30, 8192
    v_exp_f32_e32 v128, v128
    v_mfma_f32_16x16x32_bf16 v[136:139], a[132:135], a[20:23], v[136:139]
    ds_read_b64_tr_b16 a[114:115], v216 offset:36864
    v_cvt_pk_bf16_f32 v175, v158, v159
    v_mfma_f32_16x16x32_bf16 v[136:139], a[136:139], a[24:27], v[136:139]
    v_exp_f32_e32 v129, v129
    v_mfma_f32_16x16x32_bf16 v[136:139], a[140:143], a[28:31], v[136:139]
    ds_read_b64_tr_b16 a[116:117], v217 offset:32768
    ds_read_b64_tr_b16 a[118:119], v217 offset:36864
    v_mfma_f32_16x16x32_bf16 v[140:143], a[144:147], a[16:19], v[196:199]
    v_exp_f32_e32 v130, v130
    v_mfma_f32_16x16x32_bf16 v[140:143], a[148:151], a[20:23], v[140:143]
    ds_read_b64_tr_b16 a[120:121], v218 offset:32768
    v_cvt_pk_bf16_f32 v176, v128, v129
    v_mfma_f32_16x16x32_bf16 v[140:143], a[152:155], a[24:27], v[140:143]
    v_exp_f32_e32 v131, v131
    v_mfma_f32_16x16x32_bf16 v[140:143], a[156:159], a[28:31], v[140:143]
    buffer_load_dwordx4 v220, s[12:15], s36 offen nt lds
    ds_read_b64_tr_b16 a[122:123], v218 offset:36864
    v_mfma_f32_16x16x32_bf16 v[144:147], a[128:131], a[32:35], v[200:203]
    s_mov_b32 s37, 61440
    v_exp_f32_e32 v132, v132
    v_mfma_f32_16x16x32_bf16 v[144:147], a[132:135], a[36:39], v[144:147]
    ds_read_b64_tr_b16 a[124:125], v219 offset:32768
    v_cvt_pk_bf16_f32 v177, v130, v131
    v_mfma_f32_16x16x32_bf16 v[144:147], a[136:139], a[40:43], v[144:147]
    s_add_u32 m0, s30, 12288
    v_exp_f32_e32 v133, v133
    v_mfma_f32_16x16x32_bf16 v[144:147], a[140:143], a[44:47], v[144:147]
    ds_read_b64_tr_b16 a[126:127], v219 offset:36864
    buffer_load_dwordx4 v220, s[12:15], s37 offen nt lds
    v_mfma_f32_16x16x32_bf16 v[148:151], a[144:147], a[32:35], v[200:203]
    s_mov_b32 s38, 49152
    v_exp_f32_e32 v134, v134
    v_mfma_f32_16x16x32_bf16 v[148:151], a[148:151], a[36:39], v[148:151]
    s_add_u32 m0, s30, 57344
    v_cvt_pk_bf16_f32 v178, v132, v133
    v_exp_f32_e32 v135, v135
    v_mfma_f32_16x16x32_bf16 v[148:151], a[152:155], a[40:43], v[148:151]
    buffer_load_dwordx4 v221, s[20:23], s38 offen nt lds
    v_mov_b32_e32 v237, 0x53800000
    v_mfma_f32_16x16x32_bf16 v[148:151], a[156:159], a[44:47], v[148:151]
    s_mov_b32 s39, 53248
    v_exp_f32_e32 v136, v136
    v_mfma_f32_16x16x32_bf16 v[152:155], a[128:131], a[48:51], v[204:207]
    s_add_u32 m0, s30, 61440
    v_cvt_pk_bf16_f32 v179, v134, v135
    v_mfma_f32_16x16x32_bf16 v[152:155], a[132:135], a[52:55], v[152:155]
    buffer_load_dwordx4 v221, s[20:23], s39 offen nt lds
    v_mfma_f32_16x16x32_bf16 v[152:155], a[136:139], a[56:59], v[152:155]
    v_exp_f32_e32 v137, v137
    v_mfma_f32_16x16x32_bf16 v[152:155], a[140:143], a[60:63], v[152:155]
    v_exp_f32_e32 v138, v138
    v_mfma_f32_16x16x32_bf16 v[156:159], a[144:147], a[48:51], v[204:207]
    s_waitcnt vmcnt(6)
    v_cvt_pk_bf16_f32 v180, v136, v137
    v_mfma_f32_16x16x32_bf16 v[156:159], a[148:151], a[52:55], v[156:159]
    s_waitcnt lgkmcnt(0)
    v_exp_f32_e32 v139, v139
    v_mfma_f32_16x16x32_bf16 v[156:159], a[152:155], a[56:59], v[156:159]
    s_barrier
    v_mfma_f32_16x16x32_bf16 v[156:159], a[156:159], a[60:63], v[156:159]
    ds_read_b128 a[64:67], v208
    ds_read_b128 a[68:71], v209
    v_mfma_f32_16x16x32_bf16 a[224:227], a[240:243], v[160:163], a[224:227]
    ds_read_b128 a[72:75], v210
    ds_read_b128 a[76:79], v211
    v_mfma_f32_16x16x32_bf16 v[0:3], a[96:99], v[160:163], v[0:3]
    v_exp_f32_e32 v140, v140
    v_mfma_f32_16x16x32_bf16 v[4:7], a[100:103], v[160:163], v[4:7]
    ds_read_b128 a[80:83], v208 offset:4096
    v_cvt_pk_bf16_f32 v181, v138, v139
    v_mfma_f32_16x16x32_bf16 v[8:11], a[104:107], v[160:163], v[8:11]
    v_exp_f32_e32 v141, v141
    v_mfma_f32_16x16x32_bf16 v[12:15], a[108:111], v[160:163], v[12:15]
    ds_read_b128 a[84:87], v209 offset:4096
    ds_read_b128 a[88:91], v210 offset:4096
    v_mfma_f32_16x16x32_bf16 v[16:19], a[112:115], v[160:163], v[16:19]
    v_exp_f32_e32 v142, v142
    v_mfma_f32_16x16x32_bf16 v[20:23], a[116:119], v[160:163], v[20:23]
    ds_read_b128 a[92:95], v211 offset:4096
    v_cvt_pk_bf16_f32 v182, v140, v141
    v_mfma_f32_16x16x32_bf16 v[24:27], a[120:123], v[160:163], v[24:27]
    v_exp_f32_e32 v143, v143
    v_mfma_f32_16x16x32_bf16 v[28:31], a[124:127], v[160:163], v[28:31]
    v_exp_f32_e32 v144, v144
    v_mfma_f32_16x16x32_bf16 a[228:231], a[240:243], v[164:167], a[228:231]
    v_cvt_pk_bf16_f32 v183, v142, v143
    v_mfma_f32_16x16x32_bf16 v[32:35], a[96:99], v[164:167], v[32:35]
    v_exp_f32_e32 v145, v145
    v_mfma_f32_16x16x32_bf16 v[36:39], a[100:103], v[164:167], v[36:39]
    v_mfma_f32_16x16x32_bf16 v[40:43], a[104:107], v[164:167], v[40:43]
    v_exp_f32_e32 v146, v146
    v_mfma_f32_16x16x32_bf16 v[44:47], a[108:111], v[164:167], v[44:47]
    v_cvt_pk_bf16_f32 v184, v144, v145
    v_mfma_f32_16x16x32_bf16 v[48:51], a[112:115], v[164:167], v[48:51]
    v_exp_f32_e32 v147, v147
    v_mfma_f32_16x16x32_bf16 v[52:55], a[116:119], v[164:167], v[52:55]
    v_mfma_f32_16x16x32_bf16 v[56:59], a[120:123], v[164:167], v[56:59]
    v_exp_f32_e32 v148, v148
    v_mfma_f32_16x16x32_bf16 v[60:63], a[124:127], v[164:167], v[60:63]
    v_cvt_pk_bf16_f32 v185, v146, v147
    v_mfma_f32_16x16x32_bf16 a[232:235], a[240:243], v[168:171], a[232:235]
    v_exp_f32_e32 v149, v149
    v_mfma_f32_16x16x32_bf16 v[64:67], a[96:99], v[168:171], v[64:67]
    v_mfma_f32_16x16x32_bf16 v[68:71], a[100:103], v[168:171], v[68:71]
    v_exp_f32_e32 v150, v150
    v_mfma_f32_16x16x32_bf16 v[72:75], a[104:107], v[168:171], v[72:75]
    v_cvt_pk_bf16_f32 v186, v148, v149
    v_mfma_f32_16x16x32_bf16 v[76:79], a[108:111], v[168:171], v[76:79]
    v_exp_f32_e32 v151, v151
    v_mfma_f32_16x16x32_bf16 v[80:83], a[112:115], v[168:171], v[80:83]
    v_mfma_f32_16x16x32_bf16 v[84:87], a[116:119], v[168:171], v[84:87]
    v_mfma_f32_16x16x32_bf16 v[88:91], a[120:123], v[168:171], v[88:91]
    v_exp_f32_e32 v152, v152
    v_mfma_f32_16x16x32_bf16 v[92:95], a[124:127], v[168:171], v[92:95]
    v_cvt_pk_bf16_f32 v187, v150, v151
    v_mfma_f32_16x16x32_bf16 a[236:239], a[240:243], v[172:175], a[236:239]
    v_exp_f32_e32 v153, v153
    v_mfma_f32_16x16x32_bf16 v[96:99], a[96:99], v[172:175], v[96:99]
    v_mfma_f32_16x16x32_bf16 v[100:103], a[100:103], v[172:175], v[100:103]
    v_exp_f32_e32 v154, v154
    v_mfma_f32_16x16x32_bf16 v[104:107], a[104:107], v[172:175], v[104:107]
    v_cvt_pk_bf16_f32 v188, v152, v153
    v_mfma_f32_16x16x32_bf16 v[108:111], a[108:111], v[172:175], v[108:111]
    v_exp_f32_e32 v155, v155
    v_mfma_f32_16x16x32_bf16 v[112:115], a[112:115], v[172:175], v[112:115]
    s_waitcnt lgkmcnt(0)
    v_mfma_f32_16x16x32_bf16 v[116:119], a[116:119], v[172:175], v[116:119]
    v_exp_f32_e32 v156, v156
    v_mfma_f32_16x16x32_bf16 v[120:123], a[120:123], v[172:175], v[120:123]
    s_waitcnt vmcnt(4)
    v_cvt_pk_bf16_f32 v189, v154, v155
    v_mfma_f32_16x16x32_bf16 v[124:127], a[124:127], v[172:175], v[124:127]
    v_exp_f32_e32 v157, v157
    v_mfma_f32_16x16x32_bf16 v[128:131], a[64:67], a[0:3], v[192:195]
    s_barrier
    ds_read_b64_tr_b16 a[160:161], v212
    v_mfma_f32_16x16x32_bf16 v[128:131], a[68:71], a[4:7], v[128:131]
    ds_read_b64_tr_b16 a[162:163], v212 offset:4096
    ds_read_b64_tr_b16 a[164:165], v213
    v_mfma_f32_16x16x32_bf16 v[128:131], a[72:75], a[8:11], v[128:131]
    ds_read_b64_tr_b16 a[166:167], v213 offset:4096
    ds_read_b64_tr_b16 a[168:169], v214
    v_mfma_f32_16x16x32_bf16 v[128:131], a[76:79], a[12:15], v[128:131]
    s_mov_b32 s36, 65536
    v_exp_f32_e32 v158, v158
    v_mfma_f32_16x16x32_bf16 v[132:135], a[80:83], a[0:3], v[192:195]
    ds_read_b64_tr_b16 a[170:171], v214 offset:4096
    v_cvt_pk_bf16_f32 v190, v156, v157
    v_mfma_f32_16x16x32_bf16 v[132:135], a[84:87], a[4:7], v[132:135]
    s_add_u32 m0, s30, 16384
    v_exp_f32_e32 v159, v159
    v_mfma_f32_16x16x32_bf16 v[132:135], a[88:91], a[8:11], v[132:135]
    ds_read_b64_tr_b16 a[172:173], v215
    ds_read_b64_tr_b16 a[174:175], v215 offset:4096
    v_mfma_f32_16x16x32_bf16 v[132:135], a[92:95], a[12:15], v[132:135]
    ds_read_b64_tr_b16 a[176:177], v216
    ds_read_b64_tr_b16 a[178:179], v216 offset:4096
    v_mfma_f32_16x16x32_bf16 v[136:139], a[64:67], a[16:19], v[196:199]
    v_exp_f32_e32 v128, v128
    v_mfma_f32_16x16x32_bf16 v[136:139], a[68:71], a[20:23], v[136:139]
    ds_read_b64_tr_b16 a[180:181], v217
    v_cvt_pk_bf16_f32 v191, v158, v159
    v_mfma_f32_16x16x32_bf16 v[136:139], a[72:75], a[24:27], v[136:139]
    v_exp_f32_e32 v129, v129
    v_mfma_f32_16x16x32_bf16 v[136:139], a[76:79], a[28:31], v[136:139]
    ds_read_b64_tr_b16 a[182:183], v217 offset:4096
    ds_read_b64_tr_b16 a[184:185], v218
    v_mfma_f32_16x16x32_bf16 v[140:143], a[80:83], a[16:19], v[196:199]
    v_exp_f32_e32 v130, v130
    v_mfma_f32_16x16x32_bf16 v[140:143], a[84:87], a[20:23], v[140:143]
    buffer_load_dwordx4 v220, s[12:15], s36 offen nt lds
    v_cvt_pk_bf16_f32 v160, v128, v129
    v_mfma_f32_16x16x32_bf16 v[140:143], a[88:91], a[24:27], v[140:143]
    s_mov_b32 s37, 69632
    v_exp_f32_e32 v131, v131
    v_mfma_f32_16x16x32_bf16 v[140:143], a[92:95], a[28:31], v[140:143]
    ds_read_b64_tr_b16 a[186:187], v218 offset:4096
    ds_read_b64_tr_b16 a[188:189], v219
    v_mfma_f32_16x16x32_bf16 v[144:147], a[64:67], a[32:35], v[200:203]
    s_add_u32 m0, s30, 20480
    v_exp_f32_e32 v132, v132
    v_mfma_f32_16x16x32_bf16 v[144:147], a[68:71], a[36:39], v[144:147]
    ds_read_b64_tr_b16 a[190:191], v219 offset:4096
    v_cvt_pk_bf16_f32 v161, v130, v131
    v_mfma_f32_16x16x32_bf16 v[144:147], a[72:75], a[40:43], v[144:147]
    v_exp_f32_e32 v133, v133
    v_mfma_f32_16x16x32_bf16 v[144:147], a[76:79], a[44:47], v[144:147]
    buffer_load_dwordx4 v220, s[12:15], s37 offen nt lds
    v_exp_f32_e32 v134, v134
    v_mfma_f32_16x16x32_bf16 v[148:151], a[80:83], a[32:35], v[200:203]
    s_mov_b32 s38, 57344
    v_cvt_pk_bf16_f32 v162, v132, v133
    v_mfma_f32_16x16x32_bf16 v[148:151], a[84:87], a[36:39], v[148:151]
    s_add_u32 m0, s30, 65536
    v_exp_f32_e32 v135, v135
    v_mfma_f32_16x16x32_bf16 v[148:151], a[88:91], a[40:43], v[148:151]
    buffer_load_dwordx4 v221, s[20:23], s38 offen nt lds
    v_mfma_f32_16x16x32_bf16 v[148:151], a[92:95], a[44:47], v[148:151]
    s_mov_b32 s39, 61440
    v_exp_f32_e32 v136, v136
    v_mfma_f32_16x16x32_bf16 v[152:155], a[64:67], a[48:51], v[204:207]
    s_add_u32 m0, s30, 69632
    v_cvt_pk_bf16_f32 v163, v134, v135
    v_mfma_f32_16x16x32_bf16 v[152:155], a[68:71], a[52:55], v[152:155]
    buffer_load_dwordx4 v221, s[20:23], s39 offen nt lds
    v_mfma_f32_16x16x32_bf16 v[152:155], a[72:75], a[56:59], v[152:155]
    v_exp_f32_e32 v137, v137
    v_mfma_f32_16x16x32_bf16 v[152:155], a[76:79], a[60:63], v[152:155]
    v_exp_f32_e32 v138, v138
    v_mfma_f32_16x16x32_bf16 v[156:159], a[80:83], a[48:51], v[204:207]
    s_waitcnt vmcnt(6)
    v_cvt_pk_bf16_f32 v164, v136, v137
    v_mfma_f32_16x16x32_bf16 v[156:159], a[84:87], a[52:55], v[156:159]
    s_waitcnt lgkmcnt(0)
    v_exp_f32_e32 v139, v139
    v_mfma_f32_16x16x32_bf16 v[156:159], a[88:91], a[56:59], v[156:159]
    s_barrier
    v_mfma_f32_16x16x32_bf16 v[156:159], a[92:95], a[60:63], v[156:159]
    ds_read_b128 a[128:131], v208 offset:8192
    ds_read_b128 a[132:135], v209 offset:8192
    v_mfma_f32_16x16x32_bf16 a[224:227], a[240:243], v[176:179], a[224:227]
    ds_read_b128 a[136:139], v210 offset:8192
    ds_read_b128 a[140:143], v211 offset:8192
    v_mfma_f32_16x16x32_bf16 v[0:3], a[160:163], v[176:179], v[0:3]
    v_exp_f32_e32 v140, v140
    v_mfma_f32_16x16x32_bf16 v[4:7], a[164:167], v[176:179], v[4:7]
    ds_read_b128 a[144:147], v208 offset:12288
    v_cvt_pk_bf16_f32 v165, v138, v139
    v_mfma_f32_16x16x32_bf16 v[8:11], a[168:171], v[176:179], v[8:11]
    v_exp_f32_e32 v141, v141
    v_mfma_f32_16x16x32_bf16 v[12:15], a[172:175], v[176:179], v[12:15]
    ds_read_b128 a[148:151], v209 offset:12288
    ds_read_b128 a[152:155], v210 offset:12288
    v_mfma_f32_16x16x32_bf16 v[16:19], a[176:179], v[176:179], v[16:19]
    v_exp_f32_e32 v142, v142
    v_mfma_f32_16x16x32_bf16 v[20:23], a[180:183], v[176:179], v[20:23]
    ds_read_b128 a[156:159], v211 offset:12288
    v_cvt_pk_bf16_f32 v166, v140, v141
    v_mfma_f32_16x16x32_bf16 v[24:27], a[184:187], v[176:179], v[24:27]
    v_exp_f32_e32 v143, v143
    v_mfma_f32_16x16x32_bf16 v[28:31], a[188:191], v[176:179], v[28:31]
    v_exp_f32_e32 v144, v144
    v_mfma_f32_16x16x32_bf16 a[228:231], a[240:243], v[180:183], a[228:231]
    v_cvt_pk_bf16_f32 v167, v142, v143
    v_mfma_f32_16x16x32_bf16 v[32:35], a[160:163], v[180:183], v[32:35]
    v_exp_f32_e32 v145, v145
    v_mfma_f32_16x16x32_bf16 v[36:39], a[164:167], v[180:183], v[36:39]
    v_mfma_f32_16x16x32_bf16 v[40:43], a[168:171], v[180:183], v[40:43]
    v_exp_f32_e32 v146, v146
    v_mfma_f32_16x16x32_bf16 v[44:47], a[172:175], v[180:183], v[44:47]
    v_cvt_pk_bf16_f32 v168, v144, v145
    v_mfma_f32_16x16x32_bf16 v[48:51], a[176:179], v[180:183], v[48:51]
    v_exp_f32_e32 v147, v147
    v_mfma_f32_16x16x32_bf16 v[52:55], a[180:183], v[180:183], v[52:55]
    v_mfma_f32_16x16x32_bf16 v[56:59], a[184:187], v[180:183], v[56:59]
    v_exp_f32_e32 v148, v148
    v_mfma_f32_16x16x32_bf16 v[60:63], a[188:191], v[180:183], v[60:63]
    v_cvt_pk_bf16_f32 v169, v146, v147
    v_mfma_f32_16x16x32_bf16 a[232:235], a[240:243], v[184:187], a[232:235]
    v_exp_f32_e32 v149, v149
    v_mfma_f32_16x16x32_bf16 v[64:67], a[160:163], v[184:187], v[64:67]
    v_mfma_f32_16x16x32_bf16 v[68:71], a[164:167], v[184:187], v[68:71]
    v_exp_f32_e32 v150, v150
    v_mfma_f32_16x16x32_bf16 v[72:75], a[168:171], v[184:187], v[72:75]
    v_cvt_pk_bf16_f32 v170, v148, v149
    v_mfma_f32_16x16x32_bf16 v[76:79], a[172:175], v[184:187], v[76:79]
    v_exp_f32_e32 v151, v151
    v_mfma_f32_16x16x32_bf16 v[80:83], a[176:179], v[184:187], v[80:83]
    v_mfma_f32_16x16x32_bf16 v[84:87], a[180:183], v[184:187], v[84:87]
    v_mfma_f32_16x16x32_bf16 v[88:91], a[184:187], v[184:187], v[88:91]
    v_exp_f32_e32 v152, v152
    v_mfma_f32_16x16x32_bf16 v[92:95], a[188:191], v[184:187], v[92:95]
    v_cvt_pk_bf16_f32 v171, v150, v151
    v_mfma_f32_16x16x32_bf16 a[236:239], a[240:243], v[188:191], a[236:239]
    v_exp_f32_e32 v153, v153
    v_mfma_f32_16x16x32_bf16 v[96:99], a[160:163], v[188:191], v[96:99]
    v_mfma_f32_16x16x32_bf16 v[100:103], a[164:167], v[188:191], v[100:103]
    v_exp_f32_e32 v154, v154
    v_mfma_f32_16x16x32_bf16 v[104:107], a[168:171], v[188:191], v[104:107]
    v_cvt_pk_bf16_f32 v172, v152, v153
    v_mfma_f32_16x16x32_bf16 v[108:111], a[172:175], v[188:191], v[108:111]
    v_exp_f32_e32 v155, v155
    v_mfma_f32_16x16x32_bf16 v[112:115], a[176:179], v[188:191], v[112:115]
    s_waitcnt lgkmcnt(0)
    v_mfma_f32_16x16x32_bf16 v[116:119], a[180:183], v[188:191], v[116:119]
    v_exp_f32_e32 v156, v156
    v_mfma_f32_16x16x32_bf16 v[120:123], a[184:187], v[188:191], v[120:123]
    s_waitcnt vmcnt(4)
    v_cvt_pk_bf16_f32 v173, v154, v155
    v_mfma_f32_16x16x32_bf16 v[124:127], a[188:191], v[188:191], v[124:127]
    v_exp_f32_e32 v157, v157
    v_mfma_f32_16x16x32_bf16 v[128:131], a[128:131], a[0:3], v[192:195]
    s_barrier
    ds_read_b64_tr_b16 a[96:97], v212 offset:8192
    v_mfma_f32_16x16x32_bf16 v[128:131], a[132:135], a[4:7], v[128:131]
    ds_read_b64_tr_b16 a[98:99], v212 offset:12288
    ds_read_b64_tr_b16 a[100:101], v213 offset:8192
    v_mfma_f32_16x16x32_bf16 v[128:131], a[136:139], a[8:11], v[128:131]
    ds_read_b64_tr_b16 a[102:103], v213 offset:12288
    ds_read_b64_tr_b16 a[104:105], v214 offset:8192
    v_mfma_f32_16x16x32_bf16 v[128:131], a[140:143], a[12:15], v[128:131]
    s_mov_b32 s36, 73728
    v_exp_f32_e32 v158, v158
    v_mfma_f32_16x16x32_bf16 v[132:135], a[144:147], a[0:3], v[192:195]
    ds_read_b64_tr_b16 a[106:107], v214 offset:12288
    v_cvt_pk_bf16_f32 v174, v156, v157
    v_mfma_f32_16x16x32_bf16 v[132:135], a[148:151], a[4:7], v[132:135]
    s_add_u32 m0, s30, 24576
    v_exp_f32_e32 v159, v159
    v_mfma_f32_16x16x32_bf16 v[132:135], a[152:155], a[8:11], v[132:135]
    ds_read_b64_tr_b16 a[108:109], v215 offset:8192
    ds_read_b64_tr_b16 a[110:111], v215 offset:12288
    v_mfma_f32_16x16x32_bf16 v[132:135], a[156:159], a[12:15], v[132:135]
    ds_read_b64_tr_b16 a[112:113], v216 offset:8192
    ds_read_b64_tr_b16 a[114:115], v216 offset:12288
    v_mfma_f32_16x16x32_bf16 v[136:139], a[128:131], a[16:19], v[196:199]
    v_exp_f32_e32 v128, v128
    v_mfma_f32_16x16x32_bf16 v[136:139], a[132:135], a[20:23], v[136:139]
    ds_read_b64_tr_b16 a[116:117], v217 offset:8192
    v_cvt_pk_bf16_f32 v175, v158, v159
    v_mfma_f32_16x16x32_bf16 v[136:139], a[136:139], a[24:27], v[136:139]
    v_exp_f32_e32 v129, v129
    v_mfma_f32_16x16x32_bf16 v[136:139], a[140:143], a[28:31], v[136:139]
    ds_read_b64_tr_b16 a[118:119], v217 offset:12288
    ds_read_b64_tr_b16 a[120:121], v218 offset:8192
    v_mfma_f32_16x16x32_bf16 v[140:143], a[144:147], a[16:19], v[196:199]
    v_exp_f32_e32 v130, v130
    v_mfma_f32_16x16x32_bf16 v[140:143], a[148:151], a[20:23], v[140:143]
    buffer_load_dwordx4 v220, s[12:15], s36 offen nt lds
    v_cvt_pk_bf16_f32 v176, v128, v129
    v_mfma_f32_16x16x32_bf16 v[140:143], a[152:155], a[24:27], v[140:143]
    s_mov_b32 s37, 77824
    v_exp_f32_e32 v131, v131
    v_mfma_f32_16x16x32_bf16 v[140:143], a[156:159], a[28:31], v[140:143]
    ds_read_b64_tr_b16 a[122:123], v218 offset:12288
    ds_read_b64_tr_b16 a[124:125], v219 offset:8192
    v_mfma_f32_16x16x32_bf16 v[144:147], a[128:131], a[32:35], v[200:203]
    s_add_u32 m0, s30, 28672
    v_exp_f32_e32 v132, v132
    v_mfma_f32_16x16x32_bf16 v[144:147], a[132:135], a[36:39], v[144:147]
    ds_read_b64_tr_b16 a[126:127], v219 offset:12288
    v_cvt_pk_bf16_f32 v177, v130, v131
    v_mfma_f32_16x16x32_bf16 v[144:147], a[136:139], a[40:43], v[144:147]
    v_exp_f32_e32 v133, v133
    v_mfma_f32_16x16x32_bf16 v[144:147], a[140:143], a[44:47], v[144:147]
    buffer_load_dwordx4 v220, s[12:15], s37 offen nt lds
    v_exp_f32_e32 v134, v134
    v_mfma_f32_16x16x32_bf16 v[148:151], a[144:147], a[32:35], v[200:203]
    s_mov_b32 s38, 65536
    v_cvt_pk_bf16_f32 v178, v132, v133
    v_mfma_f32_16x16x32_bf16 v[148:151], a[148:151], a[36:39], v[148:151]
    s_add_u32 m0, s30, 73728
    v_exp_f32_e32 v135, v135
    v_mfma_f32_16x16x32_bf16 v[148:151], a[152:155], a[40:43], v[148:151]
    buffer_load_dwordx4 v221, s[20:23], s38 offen nt lds
    v_mfma_f32_16x16x32_bf16 v[148:151], a[156:159], a[44:47], v[148:151]
    s_mov_b32 s39, 69632
    v_exp_f32_e32 v136, v136
    v_mfma_f32_16x16x32_bf16 v[152:155], a[128:131], a[48:51], v[204:207]
    s_add_u32 m0, s30, 77824
    v_cvt_pk_bf16_f32 v179, v134, v135
    v_mfma_f32_16x16x32_bf16 v[152:155], a[132:135], a[52:55], v[152:155]
    buffer_load_dwordx4 v221, s[20:23], s39 offen nt lds
    v_mfma_f32_16x16x32_bf16 v[152:155], a[136:139], a[56:59], v[152:155]
    v_exp_f32_e32 v137, v137
    v_mfma_f32_16x16x32_bf16 v[152:155], a[140:143], a[60:63], v[152:155]
    v_exp_f32_e32 v138, v138
    v_mfma_f32_16x16x32_bf16 v[156:159], a[144:147], a[48:51], v[204:207]
    s_waitcnt vmcnt(6)
    v_cvt_pk_bf16_f32 v180, v136, v137
    v_mfma_f32_16x16x32_bf16 v[156:159], a[148:151], a[52:55], v[156:159]
    s_waitcnt lgkmcnt(0)
    v_exp_f32_e32 v139, v139
    v_mfma_f32_16x16x32_bf16 v[156:159], a[152:155], a[56:59], v[156:159]
    s_barrier
    v_mfma_f32_16x16x32_bf16 v[156:159], a[156:159], a[60:63], v[156:159]
    ds_read_b128 a[64:67], v208 offset:16384
    ds_read_b128 a[68:71], v209 offset:16384
    v_mfma_f32_16x16x32_bf16 a[224:227], a[240:243], v[160:163], a[224:227]
    ds_read_b128 a[72:75], v210 offset:16384
    ds_read_b128 a[76:79], v211 offset:16384
    v_mfma_f32_16x16x32_bf16 v[0:3], a[96:99], v[160:163], v[0:3]
    v_exp_f32_e32 v140, v140
    v_mfma_f32_16x16x32_bf16 v[4:7], a[100:103], v[160:163], v[4:7]
    ds_read_b128 a[80:83], v208 offset:20480
    v_cvt_pk_bf16_f32 v181, v138, v139
    v_mfma_f32_16x16x32_bf16 v[8:11], a[104:107], v[160:163], v[8:11]
    v_exp_f32_e32 v141, v141
    v_mfma_f32_16x16x32_bf16 v[12:15], a[108:111], v[160:163], v[12:15]
    ds_read_b128 a[84:87], v209 offset:20480
    ds_read_b128 a[88:91], v210 offset:20480
    v_mfma_f32_16x16x32_bf16 v[16:19], a[112:115], v[160:163], v[16:19]
    v_exp_f32_e32 v142, v142
    v_mfma_f32_16x16x32_bf16 v[20:23], a[116:119], v[160:163], v[20:23]
    ds_read_b128 a[92:95], v211 offset:20480
    v_cvt_pk_bf16_f32 v182, v140, v141
    v_mfma_f32_16x16x32_bf16 v[24:27], a[120:123], v[160:163], v[24:27]
    v_exp_f32_e32 v143, v143
    v_mfma_f32_16x16x32_bf16 v[28:31], a[124:127], v[160:163], v[28:31]
    v_exp_f32_e32 v144, v144
    v_mfma_f32_16x16x32_bf16 a[228:231], a[240:243], v[164:167], a[228:231]
    v_cvt_pk_bf16_f32 v183, v142, v143
    v_mfma_f32_16x16x32_bf16 v[32:35], a[96:99], v[164:167], v[32:35]
    v_exp_f32_e32 v145, v145
    v_mfma_f32_16x16x32_bf16 v[36:39], a[100:103], v[164:167], v[36:39]
    v_mfma_f32_16x16x32_bf16 v[40:43], a[104:107], v[164:167], v[40:43]
    v_exp_f32_e32 v146, v146
    v_mfma_f32_16x16x32_bf16 v[44:47], a[108:111], v[164:167], v[44:47]
    v_cvt_pk_bf16_f32 v184, v144, v145
    v_mfma_f32_16x16x32_bf16 v[48:51], a[112:115], v[164:167], v[48:51]
    v_exp_f32_e32 v147, v147
    v_mfma_f32_16x16x32_bf16 v[52:55], a[116:119], v[164:167], v[52:55]
    v_mfma_f32_16x16x32_bf16 v[56:59], a[120:123], v[164:167], v[56:59]
    v_exp_f32_e32 v148, v148
    v_mfma_f32_16x16x32_bf16 v[60:63], a[124:127], v[164:167], v[60:63]
    v_cvt_pk_bf16_f32 v185, v146, v147
    v_mfma_f32_16x16x32_bf16 a[232:235], a[240:243], v[168:171], a[232:235]
    v_exp_f32_e32 v149, v149
    v_mfma_f32_16x16x32_bf16 v[64:67], a[96:99], v[168:171], v[64:67]
    v_mfma_f32_16x16x32_bf16 v[68:71], a[100:103], v[168:171], v[68:71]
    v_exp_f32_e32 v150, v150
    v_mfma_f32_16x16x32_bf16 v[72:75], a[104:107], v[168:171], v[72:75]
    v_cvt_pk_bf16_f32 v186, v148, v149
    v_mfma_f32_16x16x32_bf16 v[76:79], a[108:111], v[168:171], v[76:79]
    v_exp_f32_e32 v151, v151
    v_mfma_f32_16x16x32_bf16 v[80:83], a[112:115], v[168:171], v[80:83]
    v_mfma_f32_16x16x32_bf16 v[84:87], a[116:119], v[168:171], v[84:87]
    v_mfma_f32_16x16x32_bf16 v[88:91], a[120:123], v[168:171], v[88:91]
    v_exp_f32_e32 v152, v152
    v_mfma_f32_16x16x32_bf16 v[92:95], a[124:127], v[168:171], v[92:95]
    v_cvt_pk_bf16_f32 v187, v150, v151
    v_mfma_f32_16x16x32_bf16 a[236:239], a[240:243], v[172:175], a[236:239]
    v_exp_f32_e32 v153, v153
    v_mfma_f32_16x16x32_bf16 v[96:99], a[96:99], v[172:175], v[96:99]
    v_mfma_f32_16x16x32_bf16 v[100:103], a[100:103], v[172:175], v[100:103]
    v_exp_f32_e32 v154, v154
    v_mfma_f32_16x16x32_bf16 v[104:107], a[104:107], v[172:175], v[104:107]
    v_cvt_pk_bf16_f32 v188, v152, v153
    v_mfma_f32_16x16x32_bf16 v[108:111], a[108:111], v[172:175], v[108:111]
    v_exp_f32_e32 v155, v155
    v_mfma_f32_16x16x32_bf16 v[112:115], a[112:115], v[172:175], v[112:115]
    s_waitcnt lgkmcnt(0)
    v_mfma_f32_16x16x32_bf16 v[116:119], a[116:119], v[172:175], v[116:119]
    v_exp_f32_e32 v156, v156
    v_mfma_f32_16x16x32_bf16 v[120:123], a[120:123], v[172:175], v[120:123]
    s_waitcnt vmcnt(4)
    v_cvt_pk_bf16_f32 v189, v154, v155
    v_mfma_f32_16x16x32_bf16 v[124:127], a[124:127], v[172:175], v[124:127]
    v_exp_f32_e32 v157, v157
    v_mfma_f32_16x16x32_bf16 v[128:131], a[64:67], a[0:3], v[192:195]
    s_barrier
    ds_read_b64_tr_b16 a[160:161], v212 offset:16384
    v_mfma_f32_16x16x32_bf16 v[128:131], a[68:71], a[4:7], v[128:131]
    ds_read_b64_tr_b16 a[162:163], v212 offset:20480
    ds_read_b64_tr_b16 a[164:165], v213 offset:16384
    v_mfma_f32_16x16x32_bf16 v[128:131], a[72:75], a[8:11], v[128:131]
    ds_read_b64_tr_b16 a[166:167], v213 offset:20480
    ds_read_b64_tr_b16 a[168:169], v214 offset:16384
    v_mfma_f32_16x16x32_bf16 v[128:131], a[76:79], a[12:15], v[128:131]
    s_mov_b32 s36, 81920
    v_exp_f32_e32 v158, v158
    v_mfma_f32_16x16x32_bf16 v[132:135], a[80:83], a[0:3], v[192:195]
    ds_read_b64_tr_b16 a[170:171], v214 offset:20480
    v_cvt_pk_bf16_f32 v190, v156, v157
    v_mfma_f32_16x16x32_bf16 v[132:135], a[84:87], a[4:7], v[132:135]
    s_add_u32 m0, s30, 32768
    v_exp_f32_e32 v159, v159
    v_mfma_f32_16x16x32_bf16 v[132:135], a[88:91], a[8:11], v[132:135]
    ds_read_b64_tr_b16 a[172:173], v215 offset:16384
    ds_read_b64_tr_b16 a[174:175], v215 offset:20480
    v_mfma_f32_16x16x32_bf16 v[132:135], a[92:95], a[12:15], v[132:135]
    ds_read_b64_tr_b16 a[176:177], v216 offset:16384
    ds_read_b64_tr_b16 a[178:179], v216 offset:20480
    v_mfma_f32_16x16x32_bf16 v[136:139], a[64:67], a[16:19], v[196:199]
    v_exp_f32_e32 v128, v128
    v_mfma_f32_16x16x32_bf16 v[136:139], a[68:71], a[20:23], v[136:139]
    buffer_load_dwordx4 v220, s[12:15], s36 offen nt lds
    v_cvt_pk_bf16_f32 v191, v158, v159
    v_mfma_f32_16x16x32_bf16 v[136:139], a[72:75], a[24:27], v[136:139]
    s_mov_b32 s37, 86016
    v_exp_f32_e32 v129, v129
    v_mfma_f32_16x16x32_bf16 v[136:139], a[76:79], a[28:31], v[136:139]
    ds_read_b64_tr_b16 a[180:181], v217 offset:16384
    ds_read_b64_tr_b16 a[182:183], v217 offset:20480
    v_mfma_f32_16x16x32_bf16 v[140:143], a[80:83], a[16:19], v[196:199]
    s_add_u32 m0, s30, 36864
    v_exp_f32_e32 v130, v130
    v_mfma_f32_16x16x32_bf16 v[140:143], a[84:87], a[20:23], v[140:143]
    ds_read_b64_tr_b16 a[184:185], v218 offset:16384
    v_cvt_pk_bf16_f32 v160, v128, v129
    v_mfma_f32_16x16x32_bf16 v[140:143], a[88:91], a[24:27], v[140:143]
    v_exp_f32_e32 v131, v131
    v_mfma_f32_16x16x32_bf16 v[140:143], a[92:95], a[28:31], v[140:143]
    ds_read_b64_tr_b16 a[186:187], v218 offset:20480
    ds_read_b64_tr_b16 a[188:189], v219 offset:16384
    v_mfma_f32_16x16x32_bf16 v[144:147], a[64:67], a[32:35], v[200:203]
    v_exp_f32_e32 v132, v132
    v_mfma_f32_16x16x32_bf16 v[144:147], a[68:71], a[36:39], v[144:147]
    ds_read_b64_tr_b16 a[190:191], v219 offset:20480
    v_cvt_pk_bf16_f32 v161, v130, v131
    v_mfma_f32_16x16x32_bf16 v[144:147], a[72:75], a[40:43], v[144:147]
    v_exp_f32_e32 v133, v133
    v_mfma_f32_16x16x32_bf16 v[144:147], a[76:79], a[44:47], v[144:147]
    buffer_load_dwordx4 v220, s[12:15], s37 offen nt lds
    v_exp_f32_e32 v134, v134
    v_mfma_f32_16x16x32_bf16 v[148:151], a[80:83], a[32:35], v[200:203]
    s_mov_b32 s38, 73728
    v_cvt_pk_bf16_f32 v162, v132, v133
    v_mfma_f32_16x16x32_bf16 v[148:151], a[84:87], a[36:39], v[148:151]
    s_add_u32 m0, s30, 81920
    v_exp_f32_e32 v135, v135
    v_mfma_f32_16x16x32_bf16 v[148:151], a[88:91], a[40:43], v[148:151]
    buffer_load_dwordx4 v221, s[20:23], s38 offen nt lds
    v_mfma_f32_16x16x32_bf16 v[148:151], a[92:95], a[44:47], v[148:151]
    s_mov_b32 s39, 77824
    v_exp_f32_e32 v136, v136
    v_mfma_f32_16x16x32_bf16 v[152:155], a[64:67], a[48:51], v[204:207]
    s_add_u32 m0, s30, 86016
    v_cvt_pk_bf16_f32 v163, v134, v135
    v_mfma_f32_16x16x32_bf16 v[152:155], a[68:71], a[52:55], v[152:155]
    buffer_load_dwordx4 v221, s[20:23], s39 offen nt lds
    v_mfma_f32_16x16x32_bf16 v[152:155], a[72:75], a[56:59], v[152:155]
    s_mov_b32 s36, 90112
    v_exp_f32_e32 v137, v137
    v_mfma_f32_16x16x32_bf16 v[152:155], a[76:79], a[60:63], v[152:155]
    s_add_u32 m0, s30, 40960
    v_exp_f32_e32 v138, v138
    v_mfma_f32_16x16x32_bf16 v[156:159], a[80:83], a[48:51], v[204:207]
    s_waitcnt vmcnt(6)
    v_cvt_pk_bf16_f32 v164, v136, v137
    v_mfma_f32_16x16x32_bf16 v[156:159], a[84:87], a[52:55], v[156:159]
    buffer_load_dwordx4 v220, s[12:15], s36 offen nt lds
    v_mfma_f32_16x16x32_bf16 v[156:159], a[88:91], a[56:59], v[156:159]
    s_barrier
    v_exp_f32_e32 v139, v139
    v_mfma_f32_16x16x32_bf16 v[156:159], a[92:95], a[60:63], v[156:159]
    ds_read_b128 a[128:131], v208 offset:24576
    ds_read_b128 a[132:135], v209 offset:24576
    v_mfma_f32_16x16x32_bf16 a[224:227], a[240:243], v[176:179], a[224:227]
    ds_read_b128 a[136:139], v210 offset:24576
    ds_read_b128 a[140:143], v211 offset:24576
    s_waitcnt lgkmcnt(15)
    v_mfma_f32_16x16x32_bf16 v[0:3], a[160:163], v[176:179], v[0:3]
    s_waitcnt lgkmcnt(4)
    v_exp_f32_e32 v140, v140
    v_mfma_f32_16x16x32_bf16 v[4:7], a[164:167], v[176:179], v[4:7]
    ds_read_b128 a[144:147], v208 offset:28672
    v_cvt_pk_bf16_f32 v165, v138, v139
    v_mfma_f32_16x16x32_bf16 v[8:11], a[168:171], v[176:179], v[8:11]
    s_mov_b32 s37, 94208
    v_exp_f32_e32 v141, v141
    v_mfma_f32_16x16x32_bf16 v[12:15], a[172:175], v[176:179], v[12:15]
    ds_read_b128 a[148:151], v209 offset:28672
    ds_read_b128 a[152:155], v210 offset:28672
    v_mfma_f32_16x16x32_bf16 v[16:19], a[176:179], v[176:179], v[16:19]
    s_add_u32 m0, s30, 45056
    v_exp_f32_e32 v142, v142
    v_mfma_f32_16x16x32_bf16 v[20:23], a[180:183], v[176:179], v[20:23]
    ds_read_b128 a[156:159], v211 offset:28672
    v_cvt_pk_bf16_f32 v166, v140, v141
    v_mfma_f32_16x16x32_bf16 v[24:27], a[184:187], v[176:179], v[24:27]
    v_exp_f32_e32 v143, v143
    v_mfma_f32_16x16x32_bf16 v[28:31], a[188:191], v[176:179], v[28:31]
    buffer_load_dwordx4 v220, s[12:15], s37 offen nt lds
    v_mfma_f32_16x16x32_bf16 a[228:231], a[240:243], v[180:183], a[228:231]
    v_exp_f32_e32 v144, v144
    v_mfma_f32_16x16x32_bf16 v[32:35], a[160:163], v[180:183], v[32:35]
    v_cvt_pk_bf16_f32 v167, v142, v143
    v_mfma_f32_16x16x32_bf16 v[36:39], a[164:167], v[180:183], v[36:39]
    v_exp_f32_e32 v145, v145
    v_mfma_f32_16x16x32_bf16 v[40:43], a[168:171], v[180:183], v[40:43]
    v_exp_f32_e32 v146, v146
    v_mfma_f32_16x16x32_bf16 v[44:47], a[172:175], v[180:183], v[44:47]
    v_cvt_pk_bf16_f32 v168, v144, v145
    v_mfma_f32_16x16x32_bf16 v[48:51], a[176:179], v[180:183], v[48:51]
    v_exp_f32_e32 v147, v147
    v_mfma_f32_16x16x32_bf16 v[52:55], a[180:183], v[180:183], v[52:55]
    v_mfma_f32_16x16x32_bf16 v[56:59], a[184:187], v[180:183], v[56:59]
    v_exp_f32_e32 v148, v148
    v_mfma_f32_16x16x32_bf16 v[60:63], a[188:191], v[180:183], v[60:63]
    v_cvt_pk_bf16_f32 v169, v146, v147
    v_mfma_f32_16x16x32_bf16 a[232:235], a[240:243], v[184:187], a[232:235]
    v_exp_f32_e32 v149, v149
    v_mfma_f32_16x16x32_bf16 v[64:67], a[160:163], v[184:187], v[64:67]
    v_mfma_f32_16x16x32_bf16 v[68:71], a[164:167], v[184:187], v[68:71]
    v_exp_f32_e32 v150, v150
    v_mfma_f32_16x16x32_bf16 v[72:75], a[168:171], v[184:187], v[72:75]
    v_cvt_pk_bf16_f32 v170, v148, v149
    v_mfma_f32_16x16x32_bf16 v[76:79], a[172:175], v[184:187], v[76:79]
    v_exp_f32_e32 v151, v151
    v_mfma_f32_16x16x32_bf16 v[80:83], a[176:179], v[184:187], v[80:83]
    v_mfma_f32_16x16x32_bf16 v[84:87], a[180:183], v[184:187], v[84:87]
    v_mfma_f32_16x16x32_bf16 v[88:91], a[184:187], v[184:187], v[88:91]
    v_exp_f32_e32 v152, v152
    v_mfma_f32_16x16x32_bf16 v[92:95], a[188:191], v[184:187], v[92:95]
    v_cvt_pk_bf16_f32 v171, v150, v151
    v_mfma_f32_16x16x32_bf16 a[236:239], a[240:243], v[188:191], a[236:239]
    v_exp_f32_e32 v153, v153
    v_mfma_f32_16x16x32_bf16 v[96:99], a[160:163], v[188:191], v[96:99]
    v_mfma_f32_16x16x32_bf16 v[100:103], a[164:167], v[188:191], v[100:103]
    v_exp_f32_e32 v154, v154
    v_mfma_f32_16x16x32_bf16 v[104:107], a[168:171], v[188:191], v[104:107]
    v_cvt_pk_bf16_f32 v172, v152, v153
    v_mfma_f32_16x16x32_bf16 v[108:111], a[172:175], v[188:191], v[108:111]
    v_exp_f32_e32 v155, v155
    v_mfma_f32_16x16x32_bf16 v[112:115], a[176:179], v[188:191], v[112:115]
    s_waitcnt lgkmcnt(0)
    v_mfma_f32_16x16x32_bf16 v[116:119], a[180:183], v[188:191], v[116:119]
    v_exp_f32_e32 v156, v156
    v_mfma_f32_16x16x32_bf16 v[120:123], a[184:187], v[188:191], v[120:123]
    s_waitcnt vmcnt(6)
    v_cvt_pk_bf16_f32 v173, v154, v155
    v_mfma_f32_16x16x32_bf16 v[124:127], a[188:191], v[188:191], v[124:127]
    v_exp_f32_e32 v157, v157
    v_mfma_f32_16x16x32_bf16 v[128:131], a[128:131], a[0:3], v[192:195]
    s_barrier
    ds_read_b64_tr_b16 a[96:97], v212 offset:24576
    v_mfma_f32_16x16x32_bf16 v[128:131], a[132:135], a[4:7], v[128:131]
    ds_read_b64_tr_b16 a[98:99], v212 offset:28672
    ds_read_b64_tr_b16 a[100:101], v213 offset:24576
    v_mfma_f32_16x16x32_bf16 v[128:131], a[136:139], a[8:11], v[128:131]
    ds_read_b64_tr_b16 a[102:103], v213 offset:28672
    ds_read_b64_tr_b16 a[104:105], v214 offset:24576
    v_mfma_f32_16x16x32_bf16 v[128:131], a[140:143], a[12:15], v[128:131]
    s_mov_b32 s38, 81920
    v_exp_f32_e32 v158, v158
    v_mfma_f32_16x16x32_bf16 v[132:135], a[144:147], a[0:3], v[192:195]
    ds_read_b64_tr_b16 a[106:107], v214 offset:28672
    v_cvt_pk_bf16_f32 v174, v156, v157
    v_mfma_f32_16x16x32_bf16 v[132:135], a[148:151], a[4:7], v[132:135]
    s_add_u32 m0, s30, 49152
    v_exp_f32_e32 v159, v159
    v_mfma_f32_16x16x32_bf16 v[132:135], a[152:155], a[8:11], v[132:135]
    ds_read_b64_tr_b16 a[108:109], v215 offset:24576
    ds_read_b64_tr_b16 a[110:111], v215 offset:28672
    v_mfma_f32_16x16x32_bf16 v[132:135], a[156:159], a[12:15], v[132:135]
    ds_read_b64_tr_b16 a[112:113], v216 offset:24576
    ds_read_b64_tr_b16 a[114:115], v216 offset:28672
    v_mfma_f32_16x16x32_bf16 v[136:139], a[128:131], a[16:19], v[196:199]
    v_exp_f32_e32 v128, v128
    v_mfma_f32_16x16x32_bf16 v[136:139], a[132:135], a[20:23], v[136:139]
    buffer_load_dwordx4 v221, s[20:23], s38 offen nt lds
    v_cvt_pk_bf16_f32 v175, v158, v159
    v_mfma_f32_16x16x32_bf16 v[136:139], a[136:139], a[24:27], v[136:139]
    s_mov_b32 s39, 86016
    v_exp_f32_e32 v129, v129
    v_mfma_f32_16x16x32_bf16 v[136:139], a[140:143], a[28:31], v[136:139]
    ds_read_b64_tr_b16 a[116:117], v217 offset:24576
    ds_read_b64_tr_b16 a[118:119], v217 offset:28672
    v_mfma_f32_16x16x32_bf16 v[140:143], a[144:147], a[16:19], v[196:199]
    s_add_u32 m0, s30, 53248
    v_exp_f32_e32 v130, v130
    v_mfma_f32_16x16x32_bf16 v[140:143], a[148:151], a[20:23], v[140:143]
    ds_read_b64_tr_b16 a[120:121], v218 offset:24576
    v_cvt_pk_bf16_f32 v176, v128, v129
    v_mfma_f32_16x16x32_bf16 v[140:143], a[152:155], a[24:27], v[140:143]
    v_exp_f32_e32 v131, v131
    v_mfma_f32_16x16x32_bf16 v[140:143], a[156:159], a[28:31], v[140:143]
    ds_read_b64_tr_b16 a[122:123], v218 offset:28672
    ds_read_b64_tr_b16 a[124:125], v219 offset:24576
    v_mfma_f32_16x16x32_bf16 v[144:147], a[128:131], a[32:35], v[200:203]
    v_exp_f32_e32 v132, v132
    v_mfma_f32_16x16x32_bf16 v[144:147], a[132:135], a[36:39], v[144:147]
    ds_read_b64_tr_b16 a[126:127], v219 offset:28672
    v_cvt_pk_bf16_f32 v177, v130, v131
    v_mfma_f32_16x16x32_bf16 v[144:147], a[136:139], a[40:43], v[144:147]
    v_exp_f32_e32 v133, v133
    v_mfma_f32_16x16x32_bf16 v[144:147], a[140:143], a[44:47], v[144:147]
    buffer_load_dwordx4 v221, s[20:23], s39 offen nt lds
    v_exp_f32_e32 v134, v134
    v_mfma_f32_16x16x32_bf16 v[148:151], a[144:147], a[32:35], v[200:203]
    s_mov_b32 s36, 98304
    v_cvt_pk_bf16_f32 v178, v132, v133
    v_mfma_f32_16x16x32_bf16 v[148:151], a[148:151], a[36:39], v[148:151]
    s_add_u32 m0, s30, 0
    v_exp_f32_e32 v135, v135
    v_mfma_f32_16x16x32_bf16 v[148:151], a[152:155], a[40:43], v[148:151]
    buffer_load_dwordx4 v220, s[12:15], s36 offen nt lds
    v_mfma_f32_16x16x32_bf16 v[148:151], a[156:159], a[44:47], v[148:151]
    s_mov_b32 s37, 102400
    v_exp_f32_e32 v136, v136
    v_mfma_f32_16x16x32_bf16 v[152:155], a[128:131], a[48:51], v[204:207]
    s_add_u32 m0, s30, 4096
    v_cvt_pk_bf16_f32 v179, v134, v135
    v_mfma_f32_16x16x32_bf16 v[152:155], a[132:135], a[52:55], v[152:155]
    buffer_load_dwordx4 v220, s[12:15], s37 offen nt lds
    v_mfma_f32_16x16x32_bf16 v[152:155], a[136:139], a[56:59], v[152:155]
    s_mov_b32 s38, 90112
    v_exp_f32_e32 v137, v137
    v_mfma_f32_16x16x32_bf16 v[152:155], a[140:143], a[60:63], v[152:155]
    s_add_u32 m0, s30, 57344
    v_exp_f32_e32 v138, v138
    v_mfma_f32_16x16x32_bf16 v[156:159], a[144:147], a[48:51], v[204:207]
    s_waitcnt vmcnt(8)
    v_cvt_pk_bf16_f32 v180, v136, v137
    v_mfma_f32_16x16x32_bf16 v[156:159], a[148:151], a[52:55], v[156:159]
    buffer_load_dwordx4 v221, s[20:23], s38 offen nt lds
    v_mfma_f32_16x16x32_bf16 v[156:159], a[152:155], a[56:59], v[156:159]
    s_barrier
    v_exp_f32_e32 v139, v139
    v_mfma_f32_16x16x32_bf16 v[156:159], a[156:159], a[60:63], v[156:159]
    ds_read_b128 a[64:67], v208 offset:32768
    ds_read_b128 a[68:71], v209 offset:32768
    v_mfma_f32_16x16x32_bf16 a[224:227], a[240:243], v[160:163], a[224:227]
    ds_read_b128 a[72:75], v210 offset:32768
    ds_read_b128 a[76:79], v211 offset:32768
    s_waitcnt lgkmcnt(15)
    v_mfma_f32_16x16x32_bf16 v[0:3], a[96:99], v[160:163], v[0:3]
    s_waitcnt lgkmcnt(4)
    v_exp_f32_e32 v140, v140
    v_mfma_f32_16x16x32_bf16 v[4:7], a[100:103], v[160:163], v[4:7]
    ds_read_b128 a[80:83], v208 offset:36864
    v_cvt_pk_bf16_f32 v181, v138, v139
    v_mfma_f32_16x16x32_bf16 v[8:11], a[104:107], v[160:163], v[8:11]
    s_mov_b32 s39, 94208
    v_exp_f32_e32 v141, v141
    v_mfma_f32_16x16x32_bf16 v[12:15], a[108:111], v[160:163], v[12:15]
    ds_read_b128 a[84:87], v209 offset:36864
    ds_read_b128 a[88:91], v210 offset:36864
    v_mfma_f32_16x16x32_bf16 v[16:19], a[112:115], v[160:163], v[16:19]
    s_add_u32 m0, s30, 61440
    v_exp_f32_e32 v142, v142
    v_mfma_f32_16x16x32_bf16 v[20:23], a[116:119], v[160:163], v[20:23]
    ds_read_b128 a[92:95], v211 offset:36864
    v_cvt_pk_bf16_f32 v182, v140, v141
    v_mfma_f32_16x16x32_bf16 v[24:27], a[120:123], v[160:163], v[24:27]
    v_exp_f32_e32 v143, v143
    v_mfma_f32_16x16x32_bf16 v[28:31], a[124:127], v[160:163], v[28:31]
    buffer_load_dwordx4 v221, s[20:23], s39 offen nt lds
    v_mfma_f32_16x16x32_bf16 a[228:231], a[240:243], v[164:167], a[228:231]
    v_exp_f32_e32 v144, v144
    v_mfma_f32_16x16x32_bf16 v[32:35], a[96:99], v[164:167], v[32:35]
    v_cvt_pk_bf16_f32 v183, v142, v143
    v_mfma_f32_16x16x32_bf16 v[36:39], a[100:103], v[164:167], v[36:39]
    v_exp_f32_e32 v145, v145
    v_mfma_f32_16x16x32_bf16 v[40:43], a[104:107], v[164:167], v[40:43]
    v_exp_f32_e32 v146, v146
    v_mfma_f32_16x16x32_bf16 v[44:47], a[108:111], v[164:167], v[44:47]
    v_cvt_pk_bf16_f32 v184, v144, v145
    v_mfma_f32_16x16x32_bf16 v[48:51], a[112:115], v[164:167], v[48:51]
    v_exp_f32_e32 v147, v147
    v_mfma_f32_16x16x32_bf16 v[52:55], a[116:119], v[164:167], v[52:55]
    v_mfma_f32_16x16x32_bf16 v[56:59], a[120:123], v[164:167], v[56:59]
    v_exp_f32_e32 v148, v148
    v_mfma_f32_16x16x32_bf16 v[60:63], a[124:127], v[164:167], v[60:63]
    v_cvt_pk_bf16_f32 v185, v146, v147
    v_mfma_f32_16x16x32_bf16 a[232:235], a[240:243], v[168:171], a[232:235]
    v_exp_f32_e32 v149, v149
    v_mfma_f32_16x16x32_bf16 v[64:67], a[96:99], v[168:171], v[64:67]
    v_mfma_f32_16x16x32_bf16 v[68:71], a[100:103], v[168:171], v[68:71]
    v_exp_f32_e32 v150, v150
    v_mfma_f32_16x16x32_bf16 v[72:75], a[104:107], v[168:171], v[72:75]
    v_cvt_pk_bf16_f32 v186, v148, v149
    v_mfma_f32_16x16x32_bf16 v[76:79], a[108:111], v[168:171], v[76:79]
    v_exp_f32_e32 v151, v151
    v_mfma_f32_16x16x32_bf16 v[80:83], a[112:115], v[168:171], v[80:83]
    v_mfma_f32_16x16x32_bf16 v[84:87], a[116:119], v[168:171], v[84:87]
    v_mfma_f32_16x16x32_bf16 v[88:91], a[120:123], v[168:171], v[88:91]
    v_exp_f32_e32 v152, v152
    v_mfma_f32_16x16x32_bf16 v[92:95], a[124:127], v[168:171], v[92:95]
    v_cvt_pk_bf16_f32 v187, v150, v151
    v_mfma_f32_16x16x32_bf16 a[236:239], a[240:243], v[172:175], a[236:239]
    v_exp_f32_e32 v153, v153
    v_mfma_f32_16x16x32_bf16 v[96:99], a[96:99], v[172:175], v[96:99]
    v_mfma_f32_16x16x32_bf16 v[100:103], a[100:103], v[172:175], v[100:103]
    v_exp_f32_e32 v154, v154
    v_mfma_f32_16x16x32_bf16 v[104:107], a[104:107], v[172:175], v[104:107]
    v_cvt_pk_bf16_f32 v188, v152, v153
    v_mfma_f32_16x16x32_bf16 v[108:111], a[108:111], v[172:175], v[108:111]
    v_exp_f32_e32 v155, v155
    v_mfma_f32_16x16x32_bf16 v[112:115], a[112:115], v[172:175], v[112:115]
    s_waitcnt lgkmcnt(0)
    v_mfma_f32_16x16x32_bf16 v[116:119], a[116:119], v[172:175], v[116:119]
    v_exp_f32_e32 v156, v156
    v_mfma_f32_16x16x32_bf16 v[120:123], a[120:123], v[172:175], v[120:123]
    s_waitcnt vmcnt(8)
    v_cvt_pk_bf16_f32 v189, v154, v155
    v_mfma_f32_16x16x32_bf16 v[124:127], a[124:127], v[172:175], v[124:127]
    v_exp_f32_e32 v157, v157
    v_mfma_f32_16x16x32_bf16 v[128:131], a[64:67], a[0:3], v[192:195]
    s_barrier
    ds_read_b64_tr_b16 a[160:161], v212 offset:32768
    v_mfma_f32_16x16x32_bf16 v[128:131], a[68:71], a[4:7], v[128:131]
    ds_read_b64_tr_b16 a[162:163], v212 offset:36864
    ds_read_b64_tr_b16 a[164:165], v213 offset:32768
    v_mfma_f32_16x16x32_bf16 v[128:131], a[72:75], a[8:11], v[128:131]
    ds_read_b64_tr_b16 a[166:167], v213 offset:36864
    ds_read_b64_tr_b16 a[168:169], v214 offset:32768
    v_mfma_f32_16x16x32_bf16 v[128:131], a[76:79], a[12:15], v[128:131]
    s_mov_b32 s36, 106496
    v_exp_f32_e32 v158, v158
    v_mfma_f32_16x16x32_bf16 v[132:135], a[80:83], a[0:3], v[192:195]
    ds_read_b64_tr_b16 a[170:171], v214 offset:36864
    v_cvt_pk_bf16_f32 v190, v156, v157
    v_mfma_f32_16x16x32_bf16 v[132:135], a[84:87], a[4:7], v[132:135]
    s_add_u32 m0, s30, 8192
    v_exp_f32_e32 v159, v159
    v_mfma_f32_16x16x32_bf16 v[132:135], a[88:91], a[8:11], v[132:135]
    ds_read_b64_tr_b16 a[172:173], v215 offset:32768
    ds_read_b64_tr_b16 a[174:175], v215 offset:36864
    v_mfma_f32_16x16x32_bf16 v[132:135], a[92:95], a[12:15], v[132:135]
    ds_read_b64_tr_b16 a[176:177], v216 offset:32768
    ds_read_b64_tr_b16 a[178:179], v216 offset:36864
    v_mfma_f32_16x16x32_bf16 v[136:139], a[64:67], a[16:19], v[196:199]
    v_exp_f32_e32 v128, v128
    v_mfma_f32_16x16x32_bf16 v[136:139], a[68:71], a[20:23], v[136:139]
    buffer_load_dwordx4 v220, s[12:15], s36 offen nt lds
    v_cvt_pk_bf16_f32 v191, v158, v159
    v_mfma_f32_16x16x32_bf16 v[136:139], a[72:75], a[24:27], v[136:139]
    s_mov_b32 s37, 110592
    v_exp_f32_e32 v129, v129
    v_mfma_f32_16x16x32_bf16 v[136:139], a[76:79], a[28:31], v[136:139]
    ds_read_b64_tr_b16 a[180:181], v217 offset:32768
    ds_read_b64_tr_b16 a[182:183], v217 offset:36864
    v_mfma_f32_16x16x32_bf16 v[140:143], a[80:83], a[16:19], v[196:199]
    s_add_u32 m0, s30, 12288
    v_exp_f32_e32 v130, v130
    v_mfma_f32_16x16x32_bf16 v[140:143], a[84:87], a[20:23], v[140:143]
    ds_read_b64_tr_b16 a[184:185], v218 offset:32768
    v_cvt_pk_bf16_f32 v160, v128, v129
    v_mfma_f32_16x16x32_bf16 v[140:143], a[88:91], a[24:27], v[140:143]
    v_exp_f32_e32 v131, v131
    v_mfma_f32_16x16x32_bf16 v[140:143], a[92:95], a[28:31], v[140:143]
    ds_read_b64_tr_b16 a[186:187], v218 offset:36864
    ds_read_b64_tr_b16 a[188:189], v219 offset:32768
    v_mfma_f32_16x16x32_bf16 v[144:147], a[64:67], a[32:35], v[200:203]
    v_exp_f32_e32 v132, v132
    v_mfma_f32_16x16x32_bf16 v[144:147], a[68:71], a[36:39], v[144:147]
    ds_read_b64_tr_b16 a[190:191], v219 offset:36864
    v_cvt_pk_bf16_f32 v161, v130, v131
    v_mfma_f32_16x16x32_bf16 v[144:147], a[72:75], a[40:43], v[144:147]
    v_exp_f32_e32 v133, v133
    v_mfma_f32_16x16x32_bf16 v[144:147], a[76:79], a[44:47], v[144:147]
    buffer_load_dwordx4 v220, s[12:15], s37 offen nt lds
    v_exp_f32_e32 v134, v134
    v_mfma_f32_16x16x32_bf16 v[148:151], a[80:83], a[32:35], v[200:203]
    s_mov_b32 s38, 98304
    v_cvt_pk_bf16_f32 v162, v132, v133
    v_mfma_f32_16x16x32_bf16 v[148:151], a[84:87], a[36:39], v[148:151]
    s_add_u32 m0, s30, 65536
    v_exp_f32_e32 v135, v135
    v_mfma_f32_16x16x32_bf16 v[148:151], a[88:91], a[40:43], v[148:151]
    buffer_load_dwordx4 v221, s[20:23], s38 offen nt lds
    v_mfma_f32_16x16x32_bf16 v[148:151], a[92:95], a[44:47], v[148:151]
    s_mov_b32 s39, 102400
    v_exp_f32_e32 v136, v136
    v_mfma_f32_16x16x32_bf16 v[152:155], a[64:67], a[48:51], v[204:207]
    s_add_u32 m0, s30, 69632
    v_cvt_pk_bf16_f32 v163, v134, v135
    v_mfma_f32_16x16x32_bf16 v[152:155], a[68:71], a[52:55], v[152:155]
    buffer_load_dwordx4 v221, s[20:23], s39 offen nt lds
    v_mfma_f32_16x16x32_bf16 v[152:155], a[72:75], a[56:59], v[152:155]
    s_mov_b32 s36, 114688
    v_exp_f32_e32 v137, v137
    v_mfma_f32_16x16x32_bf16 v[152:155], a[76:79], a[60:63], v[152:155]
    s_add_u32 m0, s30, 16384
    v_exp_f32_e32 v138, v138
    v_mfma_f32_16x16x32_bf16 v[156:159], a[80:83], a[48:51], v[204:207]
    s_waitcnt vmcnt(10)
    v_cvt_pk_bf16_f32 v164, v136, v137
    v_mfma_f32_16x16x32_bf16 v[156:159], a[84:87], a[52:55], v[156:159]
    buffer_load_dwordx4 v220, s[12:15], s36 offen nt lds
    v_mfma_f32_16x16x32_bf16 v[156:159], a[88:91], a[56:59], v[156:159]
    s_barrier
    v_exp_f32_e32 v139, v139
    v_mfma_f32_16x16x32_bf16 v[156:159], a[92:95], a[60:63], v[156:159]
    ds_read_b128 a[128:131], v208 offset:40960
    ds_read_b128 a[132:135], v209 offset:40960
    v_mfma_f32_16x16x32_bf16 a[224:227], a[240:243], v[176:179], a[224:227]
    ds_read_b128 a[136:139], v210 offset:40960
    ds_read_b128 a[140:143], v211 offset:40960
    s_waitcnt lgkmcnt(15)
    v_mfma_f32_16x16x32_bf16 v[0:3], a[160:163], v[176:179], v[0:3]
    s_waitcnt lgkmcnt(4)
    v_exp_f32_e32 v140, v140
    v_mfma_f32_16x16x32_bf16 v[4:7], a[164:167], v[176:179], v[4:7]
    ds_read_b128 a[144:147], v208 offset:45056
    v_cvt_pk_bf16_f32 v165, v138, v139
    v_mfma_f32_16x16x32_bf16 v[8:11], a[168:171], v[176:179], v[8:11]
    s_mov_b32 s37, 118784
    v_exp_f32_e32 v141, v141
    v_mfma_f32_16x16x32_bf16 v[12:15], a[172:175], v[176:179], v[12:15]
    ds_read_b128 a[148:151], v209 offset:45056
    ds_read_b128 a[152:155], v210 offset:45056
    v_mfma_f32_16x16x32_bf16 v[16:19], a[176:179], v[176:179], v[16:19]
    s_add_u32 m0, s30, 20480
    v_exp_f32_e32 v142, v142
    v_mfma_f32_16x16x32_bf16 v[20:23], a[180:183], v[176:179], v[20:23]
    ds_read_b128 a[156:159], v211 offset:45056
    v_cvt_pk_bf16_f32 v166, v140, v141
    v_mfma_f32_16x16x32_bf16 v[24:27], a[184:187], v[176:179], v[24:27]
    v_exp_f32_e32 v143, v143
    v_mfma_f32_16x16x32_bf16 v[28:31], a[188:191], v[176:179], v[28:31]
    buffer_load_dwordx4 v220, s[12:15], s37 offen nt lds
    v_mfma_f32_16x16x32_bf16 a[228:231], a[240:243], v[180:183], a[228:231]
    v_exp_f32_e32 v144, v144
    v_mfma_f32_16x16x32_bf16 v[32:35], a[160:163], v[180:183], v[32:35]
    v_cvt_pk_bf16_f32 v167, v142, v143
    v_mfma_f32_16x16x32_bf16 v[36:39], a[164:167], v[180:183], v[36:39]
    v_exp_f32_e32 v145, v145
    v_mfma_f32_16x16x32_bf16 v[40:43], a[168:171], v[180:183], v[40:43]
    v_exp_f32_e32 v146, v146
    v_mfma_f32_16x16x32_bf16 v[44:47], a[172:175], v[180:183], v[44:47]
    v_cvt_pk_bf16_f32 v168, v144, v145
    v_mfma_f32_16x16x32_bf16 v[48:51], a[176:179], v[180:183], v[48:51]
    v_exp_f32_e32 v147, v147
    v_mfma_f32_16x16x32_bf16 v[52:55], a[180:183], v[180:183], v[52:55]
    v_mfma_f32_16x16x32_bf16 v[56:59], a[184:187], v[180:183], v[56:59]
    v_exp_f32_e32 v148, v148
    v_mfma_f32_16x16x32_bf16 v[60:63], a[188:191], v[180:183], v[60:63]
    v_cvt_pk_bf16_f32 v169, v146, v147
    v_mfma_f32_16x16x32_bf16 a[232:235], a[240:243], v[184:187], a[232:235]
    v_exp_f32_e32 v149, v149
    v_mfma_f32_16x16x32_bf16 v[64:67], a[160:163], v[184:187], v[64:67]
    v_mfma_f32_16x16x32_bf16 v[68:71], a[164:167], v[184:187], v[68:71]
    v_exp_f32_e32 v150, v150
    v_mfma_f32_16x16x32_bf16 v[72:75], a[168:171], v[184:187], v[72:75]
    v_cvt_pk_bf16_f32 v170, v148, v149
    v_mfma_f32_16x16x32_bf16 v[76:79], a[172:175], v[184:187], v[76:79]
    v_exp_f32_e32 v151, v151
    v_mfma_f32_16x16x32_bf16 v[80:83], a[176:179], v[184:187], v[80:83]
    v_mfma_f32_16x16x32_bf16 v[84:87], a[180:183], v[184:187], v[84:87]
    v_mfma_f32_16x16x32_bf16 v[88:91], a[184:187], v[184:187], v[88:91]
    v_exp_f32_e32 v152, v152
    v_mfma_f32_16x16x32_bf16 v[92:95], a[188:191], v[184:187], v[92:95]
    v_cvt_pk_bf16_f32 v171, v150, v151
    v_mfma_f32_16x16x32_bf16 a[236:239], a[240:243], v[188:191], a[236:239]
    v_exp_f32_e32 v153, v153
    v_mfma_f32_16x16x32_bf16 v[96:99], a[160:163], v[188:191], v[96:99]
    v_mfma_f32_16x16x32_bf16 v[100:103], a[164:167], v[188:191], v[100:103]
    v_exp_f32_e32 v154, v154
    v_mfma_f32_16x16x32_bf16 v[104:107], a[168:171], v[188:191], v[104:107]
    v_cvt_pk_bf16_f32 v172, v152, v153
    v_mfma_f32_16x16x32_bf16 v[108:111], a[172:175], v[188:191], v[108:111]
    v_exp_f32_e32 v155, v155
    v_mfma_f32_16x16x32_bf16 v[112:115], a[176:179], v[188:191], v[112:115]
    s_waitcnt lgkmcnt(0)
    v_mfma_f32_16x16x32_bf16 v[116:119], a[180:183], v[188:191], v[116:119]
    v_exp_f32_e32 v156, v156
    v_mfma_f32_16x16x32_bf16 v[120:123], a[184:187], v[188:191], v[120:123]
    s_waitcnt vmcnt(10)
    v_cvt_pk_bf16_f32 v173, v154, v155
    v_mfma_f32_16x16x32_bf16 v[124:127], a[188:191], v[188:191], v[124:127]
    v_exp_f32_e32 v157, v157
    v_mfma_f32_16x16x32_bf16 v[128:131], a[128:131], a[0:3], v[192:195]
    s_barrier
    ds_read_b64_tr_b16 a[96:97], v212
    v_mfma_f32_16x16x32_bf16 v[128:131], a[132:135], a[4:7], v[128:131]
    ds_read_b64_tr_b16 a[98:99], v212 offset:4096
    ds_read_b64_tr_b16 a[100:101], v213
    v_mfma_f32_16x16x32_bf16 v[128:131], a[136:139], a[8:11], v[128:131]
    ds_read_b64_tr_b16 a[102:103], v213 offset:4096
    ds_read_b64_tr_b16 a[104:105], v214
    v_mfma_f32_16x16x32_bf16 v[128:131], a[140:143], a[12:15], v[128:131]
    s_mov_b32 s38, 106496
    v_exp_f32_e32 v158, v158
    v_mfma_f32_16x16x32_bf16 v[132:135], a[144:147], a[0:3], v[192:195]
    ds_read_b64_tr_b16 a[106:107], v214 offset:4096
    v_cvt_pk_bf16_f32 v174, v156, v157
    v_mfma_f32_16x16x32_bf16 v[132:135], a[148:151], a[4:7], v[132:135]
    s_add_u32 m0, s30, 73728
    v_exp_f32_e32 v159, v159
    v_mfma_f32_16x16x32_bf16 v[132:135], a[152:155], a[8:11], v[132:135]
    ds_read_b64_tr_b16 a[108:109], v215
    ds_read_b64_tr_b16 a[110:111], v215 offset:4096
    v_mfma_f32_16x16x32_bf16 v[132:135], a[156:159], a[12:15], v[132:135]
    ds_read_b64_tr_b16 a[112:113], v216
    ds_read_b64_tr_b16 a[114:115], v216 offset:4096
    v_mfma_f32_16x16x32_bf16 v[136:139], a[128:131], a[16:19], v[196:199]
    v_exp_f32_e32 v128, v128
    v_mfma_f32_16x16x32_bf16 v[136:139], a[132:135], a[20:23], v[136:139]
    buffer_load_dwordx4 v221, s[20:23], s38 offen nt lds
    v_cvt_pk_bf16_f32 v175, v158, v159
    v_mfma_f32_16x16x32_bf16 v[136:139], a[136:139], a[24:27], v[136:139]
    s_mov_b32 s39, 110592
    v_exp_f32_e32 v129, v129
    v_mfma_f32_16x16x32_bf16 v[136:139], a[140:143], a[28:31], v[136:139]
    ds_read_b64_tr_b16 a[116:117], v217
    ds_read_b64_tr_b16 a[118:119], v217 offset:4096
    v_mfma_f32_16x16x32_bf16 v[140:143], a[144:147], a[16:19], v[196:199]
    s_add_u32 m0, s30, 77824
    v_exp_f32_e32 v130, v130
    v_mfma_f32_16x16x32_bf16 v[140:143], a[148:151], a[20:23], v[140:143]
    ds_read_b64_tr_b16 a[120:121], v218
    v_cvt_pk_bf16_f32 v176, v128, v129
    v_mfma_f32_16x16x32_bf16 v[140:143], a[152:155], a[24:27], v[140:143]
    v_exp_f32_e32 v131, v131
    v_mfma_f32_16x16x32_bf16 v[140:143], a[156:159], a[28:31], v[140:143]
    ds_read_b64_tr_b16 a[122:123], v218 offset:4096
    ds_read_b64_tr_b16 a[124:125], v219
    v_mfma_f32_16x16x32_bf16 v[144:147], a[128:131], a[32:35], v[200:203]
    v_exp_f32_e32 v132, v132
    v_mfma_f32_16x16x32_bf16 v[144:147], a[132:135], a[36:39], v[144:147]
    ds_read_b64_tr_b16 a[126:127], v219 offset:4096
    v_cvt_pk_bf16_f32 v177, v130, v131
    v_mfma_f32_16x16x32_bf16 v[144:147], a[136:139], a[40:43], v[144:147]
    v_exp_f32_e32 v133, v133
    v_mfma_f32_16x16x32_bf16 v[144:147], a[140:143], a[44:47], v[144:147]
    buffer_load_dwordx4 v221, s[20:23], s39 offen nt lds
    v_exp_f32_e32 v134, v134
    v_mfma_f32_16x16x32_bf16 v[148:151], a[144:147], a[32:35], v[200:203]
    s_mov_b32 s36, 122880
    v_cvt_pk_bf16_f32 v178, v132, v133
    v_mfma_f32_16x16x32_bf16 v[148:151], a[148:151], a[36:39], v[148:151]
    s_add_u32 m0, s30, 24576
    v_exp_f32_e32 v135, v135
    v_mfma_f32_16x16x32_bf16 v[148:151], a[152:155], a[40:43], v[148:151]
    buffer_load_dwordx4 v220, s[12:15], s36 offen nt lds
    v_mfma_f32_16x16x32_bf16 v[148:151], a[156:159], a[44:47], v[148:151]
    s_mov_b32 s37, 126976
    v_exp_f32_e32 v136, v136
    v_mfma_f32_16x16x32_bf16 v[152:155], a[128:131], a[48:51], v[204:207]
    s_add_u32 m0, s30, 28672
    v_cvt_pk_bf16_f32 v179, v134, v135
    v_mfma_f32_16x16x32_bf16 v[152:155], a[132:135], a[52:55], v[152:155]
    buffer_load_dwordx4 v220, s[12:15], s37 offen nt lds
    v_mfma_f32_16x16x32_bf16 v[152:155], a[136:139], a[56:59], v[152:155]
    s_mov_b32 s38, 114688
    v_exp_f32_e32 v137, v137
    v_mfma_f32_16x16x32_bf16 v[152:155], a[140:143], a[60:63], v[152:155]
    s_add_u32 m0, s30, 81920
    v_exp_f32_e32 v138, v138
    v_mfma_f32_16x16x32_bf16 v[156:159], a[144:147], a[48:51], v[204:207]
    s_waitcnt vmcnt(12)
    v_cvt_pk_bf16_f32 v180, v136, v137
    v_mfma_f32_16x16x32_bf16 v[156:159], a[148:151], a[52:55], v[156:159]
    buffer_load_dwordx4 v221, s[20:23], s38 offen nt lds
    v_mfma_f32_16x16x32_bf16 v[156:159], a[152:155], a[56:59], v[156:159]
    s_barrier
    v_exp_f32_e32 v139, v139
    v_mfma_f32_16x16x32_bf16 v[156:159], a[156:159], a[60:63], v[156:159]
    ds_read_b128 a[64:67], v208
    ds_read_b128 a[68:71], v209
    v_mfma_f32_16x16x32_bf16 a[224:227], a[240:243], v[160:163], a[224:227]
    ds_read_b128 a[72:75], v210
    ds_read_b128 a[76:79], v211
    s_waitcnt lgkmcnt(15)
    v_mfma_f32_16x16x32_bf16 v[0:3], a[96:99], v[160:163], v[0:3]
    s_waitcnt lgkmcnt(4)
    v_exp_f32_e32 v140, v140
    v_mfma_f32_16x16x32_bf16 v[4:7], a[100:103], v[160:163], v[4:7]
    ds_read_b128 a[80:83], v208 offset:4096
    v_cvt_pk_bf16_f32 v181, v138, v139
    v_mfma_f32_16x16x32_bf16 v[8:11], a[104:107], v[160:163], v[8:11]
    s_mov_b32 s39, 118784
    v_exp_f32_e32 v141, v141
    v_mfma_f32_16x16x32_bf16 v[12:15], a[108:111], v[160:163], v[12:15]
    ds_read_b128 a[84:87], v209 offset:4096
    ds_read_b128 a[88:91], v210 offset:4096
    v_mfma_f32_16x16x32_bf16 v[16:19], a[112:115], v[160:163], v[16:19]
    s_add_u32 m0, s30, 86016
    v_exp_f32_e32 v142, v142
    v_mfma_f32_16x16x32_bf16 v[20:23], a[116:119], v[160:163], v[20:23]
    ds_read_b128 a[92:95], v211 offset:4096
    v_cvt_pk_bf16_f32 v182, v140, v141
    v_mfma_f32_16x16x32_bf16 v[24:27], a[120:123], v[160:163], v[24:27]
    v_exp_f32_e32 v143, v143
    v_mfma_f32_16x16x32_bf16 v[28:31], a[124:127], v[160:163], v[28:31]
    buffer_load_dwordx4 v221, s[20:23], s39 offen nt lds
    v_mfma_f32_16x16x32_bf16 a[228:231], a[240:243], v[164:167], a[228:231]
    v_exp_f32_e32 v144, v144
    v_mfma_f32_16x16x32_bf16 v[32:35], a[96:99], v[164:167], v[32:35]
    v_cvt_pk_bf16_f32 v183, v142, v143
    v_mfma_f32_16x16x32_bf16 v[36:39], a[100:103], v[164:167], v[36:39]
    v_exp_f32_e32 v145, v145
    v_mfma_f32_16x16x32_bf16 v[40:43], a[104:107], v[164:167], v[40:43]
    v_exp_f32_e32 v146, v146
    v_mfma_f32_16x16x32_bf16 v[44:47], a[108:111], v[164:167], v[44:47]
    v_cvt_pk_bf16_f32 v184, v144, v145
    v_mfma_f32_16x16x32_bf16 v[48:51], a[112:115], v[164:167], v[48:51]
    v_exp_f32_e32 v147, v147
    v_mfma_f32_16x16x32_bf16 v[52:55], a[116:119], v[164:167], v[52:55]
    v_mfma_f32_16x16x32_bf16 v[56:59], a[120:123], v[164:167], v[56:59]
    v_exp_f32_e32 v148, v148
    v_mfma_f32_16x16x32_bf16 v[60:63], a[124:127], v[164:167], v[60:63]
    v_cvt_pk_bf16_f32 v185, v146, v147
    v_mfma_f32_16x16x32_bf16 a[232:235], a[240:243], v[168:171], a[232:235]
    v_exp_f32_e32 v149, v149
    v_mfma_f32_16x16x32_bf16 v[64:67], a[96:99], v[168:171], v[64:67]
    v_mfma_f32_16x16x32_bf16 v[68:71], a[100:103], v[168:171], v[68:71]
    v_exp_f32_e32 v150, v150
    v_mfma_f32_16x16x32_bf16 v[72:75], a[104:107], v[168:171], v[72:75]
    v_cvt_pk_bf16_f32 v186, v148, v149
    v_mfma_f32_16x16x32_bf16 v[76:79], a[108:111], v[168:171], v[76:79]
    v_exp_f32_e32 v151, v151
    v_mfma_f32_16x16x32_bf16 v[80:83], a[112:115], v[168:171], v[80:83]
    v_mfma_f32_16x16x32_bf16 v[84:87], a[116:119], v[168:171], v[84:87]
    v_mfma_f32_16x16x32_bf16 v[88:91], a[120:123], v[168:171], v[88:91]
    v_exp_f32_e32 v152, v152
    v_mfma_f32_16x16x32_bf16 v[92:95], a[124:127], v[168:171], v[92:95]
    v_cvt_pk_bf16_f32 v187, v150, v151
    v_mfma_f32_16x16x32_bf16 a[236:239], a[240:243], v[172:175], a[236:239]
    v_exp_f32_e32 v153, v153
    v_mfma_f32_16x16x32_bf16 v[96:99], a[96:99], v[172:175], v[96:99]
    v_mfma_f32_16x16x32_bf16 v[100:103], a[100:103], v[172:175], v[100:103]
    v_exp_f32_e32 v154, v154
    v_mfma_f32_16x16x32_bf16 v[104:107], a[104:107], v[172:175], v[104:107]
    v_cvt_pk_bf16_f32 v188, v152, v153
    v_mfma_f32_16x16x32_bf16 v[108:111], a[108:111], v[172:175], v[108:111]
    v_exp_f32_e32 v155, v155
    v_mfma_f32_16x16x32_bf16 v[112:115], a[112:115], v[172:175], v[112:115]
    s_waitcnt lgkmcnt(0)
    v_mfma_f32_16x16x32_bf16 v[116:119], a[116:119], v[172:175], v[116:119]
    v_exp_f32_e32 v156, v156
    v_mfma_f32_16x16x32_bf16 v[120:123], a[120:123], v[172:175], v[120:123]
    s_waitcnt vmcnt(8)
    v_cvt_pk_bf16_f32 v189, v154, v155
    v_mfma_f32_16x16x32_bf16 v[124:127], a[124:127], v[172:175], v[124:127]
    v_exp_f32_e32 v157, v157
    v_mfma_f32_16x16x32_bf16 v[128:131], a[64:67], a[0:3], v[192:195]
    s_barrier
    ds_read_b64_tr_b16 a[160:161], v212 offset:8192
    v_mfma_f32_16x16x32_bf16 v[128:131], a[68:71], a[4:7], v[128:131]
    ds_read_b64_tr_b16 a[162:163], v212 offset:12288
    ds_read_b64_tr_b16 a[164:165], v213 offset:8192
    v_mfma_f32_16x16x32_bf16 v[128:131], a[72:75], a[8:11], v[128:131]
    ds_read_b64_tr_b16 a[166:167], v213 offset:12288
    ds_read_b64_tr_b16 a[168:169], v214 offset:8192
    v_mfma_f32_16x16x32_bf16 v[128:131], a[76:79], a[12:15], v[128:131]
    s_mov_b32 s36, 122880
    v_exp_f32_e32 v158, v158
    v_mfma_f32_16x16x32_bf16 v[132:135], a[80:83], a[0:3], v[192:195]
    ds_read_b64_tr_b16 a[170:171], v214 offset:12288
    v_cvt_pk_bf16_f32 v190, v156, v157
    v_mfma_f32_16x16x32_bf16 v[132:135], a[84:87], a[4:7], v[132:135]
    s_add_u32 m0, s30, 49152
    v_exp_f32_e32 v159, v159
    v_mfma_f32_16x16x32_bf16 v[132:135], a[88:91], a[8:11], v[132:135]
    ds_read_b64_tr_b16 a[172:173], v215 offset:8192
    ds_read_b64_tr_b16 a[174:175], v215 offset:12288
    v_mfma_f32_16x16x32_bf16 v[132:135], a[92:95], a[12:15], v[132:135]
    ds_read_b64_tr_b16 a[176:177], v216 offset:8192
    ds_read_b64_tr_b16 a[178:179], v216 offset:12288
    v_mfma_f32_16x16x32_bf16 v[136:139], a[64:67], a[16:19], v[196:199]
    v_exp_f32_e32 v128, v128
    v_mfma_f32_16x16x32_bf16 v[136:139], a[68:71], a[20:23], v[136:139]
    ds_read_b64_tr_b16 a[180:181], v217 offset:8192
    v_cvt_pk_bf16_f32 v191, v158, v159
    v_mfma_f32_16x16x32_bf16 v[136:139], a[72:75], a[24:27], v[136:139]
    v_exp_f32_e32 v129, v129
    v_mfma_f32_16x16x32_bf16 v[136:139], a[76:79], a[28:31], v[136:139]
    ds_read_b64_tr_b16 a[182:183], v217 offset:12288
    ds_read_b64_tr_b16 a[184:185], v218 offset:8192
    v_mfma_f32_16x16x32_bf16 v[140:143], a[80:83], a[16:19], v[196:199]
    v_exp_f32_e32 v130, v130
    v_mfma_f32_16x16x32_bf16 v[140:143], a[84:87], a[20:23], v[140:143]
    ds_read_b64_tr_b16 a[186:187], v218 offset:12288
    v_cvt_pk_bf16_f32 v160, v128, v129
    v_mfma_f32_16x16x32_bf16 v[140:143], a[88:91], a[24:27], v[140:143]
    v_exp_f32_e32 v131, v131
    v_mfma_f32_16x16x32_bf16 v[140:143], a[92:95], a[28:31], v[140:143]
    ds_read_b64_tr_b16 a[188:189], v219 offset:8192
    ds_read_b64_tr_b16 a[190:191], v219 offset:12288
    v_mfma_f32_16x16x32_bf16 v[144:147], a[64:67], a[32:35], v[200:203]
    v_exp_f32_e32 v132, v132
    v_mfma_f32_16x16x32_bf16 v[144:147], a[68:71], a[36:39], v[144:147]
    ds_read_b64_tr_b16 a[96:97], v212 offset:16384
    v_cvt_pk_bf16_f32 v161, v130, v131
    v_mfma_f32_16x16x32_bf16 v[144:147], a[72:75], a[40:43], v[144:147]
    v_exp_f32_e32 v133, v133
    v_mfma_f32_16x16x32_bf16 v[144:147], a[76:79], a[44:47], v[144:147]
    ds_read_b64_tr_b16 a[98:99], v212 offset:20480
    buffer_load_dwordx4 v221, s[20:23], s36 offen nt lds
    v_mfma_f32_16x16x32_bf16 v[148:151], a[80:83], a[32:35], v[200:203]
    s_mov_b32 s37, 126976
    v_exp_f32_e32 v134, v134
    v_mfma_f32_16x16x32_bf16 v[148:151], a[84:87], a[36:39], v[148:151]
    ds_read_b64_tr_b16 a[100:101], v213 offset:16384
    v_cvt_pk_bf16_f32 v162, v132, v133
    v_mfma_f32_16x16x32_bf16 v[148:151], a[88:91], a[40:43], v[148:151]
    s_add_u32 m0, s30, 53248
    v_exp_f32_e32 v135, v135
    v_mfma_f32_16x16x32_bf16 v[148:151], a[92:95], a[44:47], v[148:151]
    ds_read_b64_tr_b16 a[102:103], v213 offset:20480
    ds_read_b64_tr_b16 a[104:105], v214 offset:16384
    v_mfma_f32_16x16x32_bf16 v[152:155], a[64:67], a[48:51], v[204:207]
    ds_read_b64_tr_b16 a[106:107], v214 offset:20480
    ds_read_b64_tr_b16 a[108:109], v215 offset:16384
    v_mfma_f32_16x16x32_bf16 v[152:155], a[68:71], a[52:55], v[152:155]
    v_exp_f32_e32 v136, v136
    v_mfma_f32_16x16x32_bf16 v[152:155], a[72:75], a[56:59], v[152:155]
    ds_read_b64_tr_b16 a[110:111], v215 offset:20480
    v_cvt_pk_bf16_f32 v163, v134, v135
    v_mfma_f32_16x16x32_bf16 v[152:155], a[76:79], a[60:63], v[152:155]
    v_exp_f32_e32 v137, v137
    v_mfma_f32_16x16x32_bf16 v[156:159], a[80:83], a[48:51], v[204:207]
    s_waitcnt vmcnt(11)
    v_exp_f32_e32 v138, v138
    v_mfma_f32_16x16x32_bf16 v[156:159], a[84:87], a[52:55], v[156:159]
    ds_read_b64_tr_b16 a[112:113], v216 offset:16384
    ds_read_b64_tr_b16 a[114:115], v216 offset:20480
    v_mfma_f32_16x16x32_bf16 v[156:159], a[88:91], a[56:59], v[156:159]
    s_barrier
    v_cvt_pk_bf16_f32 v164, v136, v137
    v_exp_f32_e32 v139, v139
    v_mfma_f32_16x16x32_bf16 v[156:159], a[92:95], a[60:63], v[156:159]
    ds_read_b128 a[128:131], v208 offset:8192
    ds_read_b128 a[132:135], v209 offset:8192
    v_mfma_f32_16x16x32_bf16 a[224:227], a[240:243], v[176:179], a[224:227]
    ds_read_b128 a[136:139], v210 offset:8192
    ds_read_b128 a[140:143], v211 offset:8192
    s_waitcnt lgkmcnt(15)
    v_mfma_f32_16x16x32_bf16 v[0:3], a[160:163], v[176:179], v[0:3]
    v_exp_f32_e32 v140, v140
    v_mfma_f32_16x16x32_bf16 v[4:7], a[164:167], v[176:179], v[4:7]
    ds_read_b128 a[144:147], v208 offset:12288
    v_cvt_pk_bf16_f32 v165, v138, v139
    v_mfma_f32_16x16x32_bf16 v[8:11], a[168:171], v[176:179], v[8:11]
    v_exp_f32_e32 v141, v141
    v_mfma_f32_16x16x32_bf16 v[12:15], a[172:175], v[176:179], v[12:15]
    ds_read_b128 a[148:151], v209 offset:12288
    ds_read_b64_tr_b16 a[116:117], v217 offset:16384
    v_mfma_f32_16x16x32_bf16 v[16:19], a[176:179], v[176:179], v[16:19]
    s_waitcnt lgkmcnt(5)
    v_exp_f32_e32 v142, v142
    v_mfma_f32_16x16x32_bf16 v[20:23], a[180:183], v[176:179], v[20:23]
    ds_read_b128 a[152:155], v210 offset:12288
    v_cvt_pk_bf16_f32 v166, v140, v141
    v_mfma_f32_16x16x32_bf16 v[24:27], a[184:187], v[176:179], v[24:27]
    v_exp_f32_e32 v143, v143
    v_mfma_f32_16x16x32_bf16 v[28:31], a[188:191], v[176:179], v[28:31]
    ds_read_b64_tr_b16 a[118:119], v217 offset:20480
    ds_read_b128 a[156:159], v211 offset:12288
    v_mfma_f32_16x16x32_bf16 a[228:231], a[240:243], v[180:183], a[228:231]
    ds_read_b64_tr_b16 a[120:121], v218 offset:16384
    ds_read_b64_tr_b16 a[122:123], v218 offset:20480
    v_mfma_f32_16x16x32_bf16 v[32:35], a[160:163], v[180:183], v[32:35]
    v_exp_f32_e32 v144, v144
    v_mfma_f32_16x16x32_bf16 v[36:39], a[164:167], v[180:183], v[36:39]
    ds_read_b64_tr_b16 a[124:125], v219 offset:16384
    v_cvt_pk_bf16_f32 v167, v142, v143
    v_mfma_f32_16x16x32_bf16 v[40:43], a[168:171], v[180:183], v[40:43]
    v_exp_f32_e32 v145, v145
    v_mfma_f32_16x16x32_bf16 v[44:47], a[172:175], v[180:183], v[44:47]
    ds_read_b64_tr_b16 a[126:127], v219 offset:20480
    buffer_load_dwordx4 v221, s[20:23], s37 offen nt lds
    v_mfma_f32_16x16x32_bf16 v[48:51], a[176:179], v[180:183], v[48:51]
    v_exp_f32_e32 v146, v146
    v_mfma_f32_16x16x32_bf16 v[52:55], a[180:183], v[180:183], v[52:55]
    v_cvt_pk_bf16_f32 v168, v144, v145
    v_exp_f32_e32 v147, v147
    v_mfma_f32_16x16x32_bf16 v[56:59], a[184:187], v[180:183], v[56:59]
    v_exp_f32_e32 v148, v148
    v_mfma_f32_16x16x32_bf16 v[60:63], a[188:191], v[180:183], v[60:63]
    v_cvt_pk_bf16_f32 v169, v146, v147
    v_mfma_f32_16x16x32_bf16 a[232:235], a[240:243], v[184:187], a[232:235]
    v_exp_f32_e32 v149, v149
    v_mfma_f32_16x16x32_bf16 v[64:67], a[160:163], v[184:187], v[64:67]
    v_mfma_f32_16x16x32_bf16 v[68:71], a[164:167], v[184:187], v[68:71]
    v_exp_f32_e32 v150, v150
    v_mfma_f32_16x16x32_bf16 v[72:75], a[168:171], v[184:187], v[72:75]
    v_cvt_pk_bf16_f32 v170, v148, v149
    v_mfma_f32_16x16x32_bf16 v[76:79], a[172:175], v[184:187], v[76:79]
    v_exp_f32_e32 v151, v151
    v_mfma_f32_16x16x32_bf16 v[80:83], a[176:179], v[184:187], v[80:83]
    v_mfma_f32_16x16x32_bf16 v[84:87], a[180:183], v[184:187], v[84:87]
    v_mfma_f32_16x16x32_bf16 v[88:91], a[184:187], v[184:187], v[88:91]
    v_exp_f32_e32 v152, v152
    v_mfma_f32_16x16x32_bf16 v[92:95], a[188:191], v[184:187], v[92:95]
    v_cvt_pk_bf16_f32 v171, v150, v151
    v_mfma_f32_16x16x32_bf16 a[236:239], a[240:243], v[188:191], a[236:239]
    v_exp_f32_e32 v153, v153
    v_mfma_f32_16x16x32_bf16 v[96:99], a[160:163], v[188:191], v[96:99]
    v_mfma_f32_16x16x32_bf16 v[100:103], a[164:167], v[188:191], v[100:103]
    v_exp_f32_e32 v154, v154
    v_mfma_f32_16x16x32_bf16 v[104:107], a[168:171], v[188:191], v[104:107]
    v_cvt_pk_bf16_f32 v172, v152, v153
    v_mfma_f32_16x16x32_bf16 v[108:111], a[172:175], v[188:191], v[108:111]
    v_exp_f32_e32 v155, v155
    v_mfma_f32_16x16x32_bf16 v[112:115], a[176:179], v[188:191], v[112:115]
    v_mfma_f32_16x16x32_bf16 v[116:119], a[180:183], v[188:191], v[116:119]
    v_exp_f32_e32 v156, v156
    v_mfma_f32_16x16x32_bf16 v[120:123], a[184:187], v[188:191], v[120:123]
    s_waitcnt vmcnt(6)
    v_cvt_pk_bf16_f32 v173, v154, v155
    v_mfma_f32_16x16x32_bf16 v[124:127], a[188:191], v[188:191], v[124:127]
    s_waitcnt lgkmcnt(0)
    v_exp_f32_e32 v157, v157
    v_mfma_f32_16x16x32_bf16 v[128:131], a[128:131], a[0:3], v[192:195]
    s_barrier
    v_mfma_f32_16x16x32_bf16 v[128:131], a[132:135], a[4:7], v[128:131]
    ds_read_b64_tr_b16 a[160:161], v212 offset:24576
    ds_read_b64_tr_b16 a[162:163], v212 offset:28672
    v_mfma_f32_16x16x32_bf16 v[128:131], a[136:139], a[8:11], v[128:131]
    ds_read_b64_tr_b16 a[164:165], v213 offset:24576
    ds_read_b64_tr_b16 a[166:167], v213 offset:28672
    v_mfma_f32_16x16x32_bf16 v[128:131], a[140:143], a[12:15], v[128:131]
    v_exp_f32_e32 v158, v158
    v_mfma_f32_16x16x32_bf16 v[132:135], a[144:147], a[0:3], v[192:195]
    ds_read_b64_tr_b16 a[168:169], v214 offset:24576
    v_cvt_pk_bf16_f32 v174, v156, v157
    v_mfma_f32_16x16x32_bf16 v[132:135], a[148:151], a[4:7], v[132:135]
    v_exp_f32_e32 v159, v159
    v_mfma_f32_16x16x32_bf16 v[132:135], a[152:155], a[8:11], v[132:135]
    ds_read_b64_tr_b16 a[170:171], v214 offset:28672
    ds_read_b64_tr_b16 a[172:173], v215 offset:24576
    v_mfma_f32_16x16x32_bf16 v[132:135], a[156:159], a[12:15], v[132:135]
    ds_read_b128 a[64:67], v208 offset:16384
    ds_read_b64_tr_b16 a[174:175], v215 offset:28672
    v_mfma_f32_16x16x32_bf16 v[136:139], a[128:131], a[16:19], v[196:199]
    v_exp_f32_e32 v128, v128
    v_mfma_f32_16x16x32_bf16 v[136:139], a[132:135], a[20:23], v[136:139]
    ds_read_b128 a[68:71], v209 offset:16384
    v_cvt_pk_bf16_f32 v175, v158, v159
    v_mfma_f32_16x16x32_bf16 v[136:139], a[136:139], a[24:27], v[136:139]
    v_exp_f32_e32 v129, v129
    v_mfma_f32_16x16x32_bf16 v[136:139], a[140:143], a[28:31], v[136:139]
    ds_read_b64_tr_b16 a[176:177], v216 offset:24576
    ds_read_b128 a[72:75], v210 offset:16384
    v_mfma_f32_16x16x32_bf16 v[140:143], a[144:147], a[16:19], v[196:199]
    v_exp_f32_e32 v130, v130
    v_mfma_f32_16x16x32_bf16 v[140:143], a[148:151], a[20:23], v[140:143]
    ds_read_b128 a[76:79], v211 offset:16384
    v_cvt_pk_bf16_f32 v176, v128, v129
    v_mfma_f32_16x16x32_bf16 v[140:143], a[152:155], a[24:27], v[140:143]
    v_exp_f32_e32 v131, v131
    v_mfma_f32_16x16x32_bf16 v[140:143], a[156:159], a[28:31], v[140:143]
    ds_read_b64_tr_b16 a[178:179], v216 offset:28672
    ds_read_b128 a[80:83], v208 offset:20480
    v_mfma_f32_16x16x32_bf16 a[224:227], a[240:243], v[160:163], a[224:227]
    v_exp_f32_e32 v132, v132
    v_mfma_f32_16x16x32_bf16 v[0:3], a[96:99], v[160:163], v[0:3]
    ds_read_b64_tr_b16 a[180:181], v217 offset:24576
    v_cvt_pk_bf16_f32 v177, v130, v131
    v_mfma_f32_16x16x32_bf16 v[4:7], a[100:103], v[160:163], v[4:7]
    v_exp_f32_e32 v133, v133
    v_mfma_f32_16x16x32_bf16 v[8:11], a[104:107], v[160:163], v[8:11]
    ds_read_b128 a[84:87], v209 offset:20480
    ds_read_b64_tr_b16 a[182:183], v217 offset:28672
    v_mfma_f32_16x16x32_bf16 v[12:15], a[108:111], v[160:163], v[12:15]
    v_exp_f32_e32 v134, v134
    v_mfma_f32_16x16x32_bf16 v[16:19], a[112:115], v[160:163], v[16:19]
    ds_read_b128 a[88:91], v210 offset:20480
    v_cvt_pk_bf16_f32 v178, v132, v133
    v_mfma_f32_16x16x32_bf16 v[20:23], a[116:119], v[160:163], v[20:23]
    v_exp_f32_e32 v135, v135
    v_mfma_f32_16x16x32_bf16 v[24:27], a[120:123], v[160:163], v[24:27]
    ds_read_b128 a[92:95], v211 offset:20480
    ds_read_b64_tr_b16 a[184:185], v218 offset:24576
    v_mfma_f32_16x16x32_bf16 v[28:31], a[124:127], v[160:163], v[28:31]
    ds_read_b64_tr_b16 a[186:187], v218 offset:28672
    ds_read_b64_tr_b16 a[188:189], v219 offset:24576
    v_mfma_f32_16x16x32_bf16 a[228:231], a[240:243], v[164:167], a[228:231]
    v_exp_f32_e32 v136, v136
    v_mfma_f32_16x16x32_bf16 v[32:35], a[96:99], v[164:167], v[32:35]
    ds_read_b64_tr_b16 a[190:191], v219 offset:28672
    v_cvt_pk_bf16_f32 v179, v134, v135
    v_mfma_f32_16x16x32_bf16 v[36:39], a[100:103], v[164:167], v[36:39]
    v_exp_f32_e32 v137, v137
    v_mfma_f32_16x16x32_bf16 v[40:43], a[104:107], v[164:167], v[40:43]
    v_exp_f32_e32 v138, v138
    v_mfma_f32_16x16x32_bf16 v[44:47], a[108:111], v[164:167], v[44:47]
    v_cvt_pk_bf16_f32 v180, v136, v137
    v_mfma_f32_16x16x32_bf16 v[48:51], a[112:115], v[164:167], v[48:51]
    s_waitcnt lgkmcnt(1)
    v_exp_f32_e32 v139, v139
    v_mfma_f32_16x16x32_bf16 v[52:55], a[116:119], v[164:167], v[52:55]
    v_exp_f32_e32 v140, v140
    v_mfma_f32_16x16x32_bf16 v[56:59], a[120:123], v[164:167], v[56:59]
    s_waitcnt vmcnt(2)
    v_cvt_pk_bf16_f32 v181, v138, v139
    v_mfma_f32_16x16x32_bf16 v[60:63], a[124:127], v[164:167], v[60:63]
    v_exp_f32_e32 v141, v141
    v_mfma_f32_16x16x32_bf16 v[128:131], a[64:67], a[0:3], v[192:195]
    s_barrier
    v_mfma_f32_16x16x32_bf16 v[128:131], a[68:71], a[4:7], v[128:131]
    ds_read_b64_tr_b16 a[96:97], v212 offset:32768
    ds_read_b64_tr_b16 a[98:99], v212 offset:36864
    v_mfma_f32_16x16x32_bf16 v[128:131], a[72:75], a[8:11], v[128:131]
    ds_read_b64_tr_b16 a[100:101], v213 offset:32768
    ds_read_b64_tr_b16 a[102:103], v213 offset:36864
    v_mfma_f32_16x16x32_bf16 v[128:131], a[76:79], a[12:15], v[128:131]
    v_exp_f32_e32 v142, v142
    v_mfma_f32_16x16x32_bf16 v[132:135], a[80:83], a[0:3], v[192:195]
    ds_read_b64_tr_b16 a[104:105], v214 offset:32768
    v_cvt_pk_bf16_f32 v182, v140, v141
    v_mfma_f32_16x16x32_bf16 v[132:135], a[84:87], a[4:7], v[132:135]
    v_exp_f32_e32 v143, v143
    v_mfma_f32_16x16x32_bf16 v[132:135], a[88:91], a[8:11], v[132:135]
    ds_read_b64_tr_b16 a[106:107], v214 offset:36864
    ds_read_b64_tr_b16 a[108:109], v215 offset:32768
    v_mfma_f32_16x16x32_bf16 v[132:135], a[92:95], a[12:15], v[132:135]
    ds_read_b128 a[128:131], v208 offset:24576
    ds_read_b64_tr_b16 a[110:111], v215 offset:36864
    v_mfma_f32_16x16x32_bf16 v[136:139], a[64:67], a[16:19], v[196:199]
    v_exp_f32_e32 v128, v128
    v_mfma_f32_16x16x32_bf16 v[136:139], a[68:71], a[20:23], v[136:139]
    ds_read_b128 a[132:135], v209 offset:24576
    v_cvt_pk_bf16_f32 v183, v142, v143
    v_mfma_f32_16x16x32_bf16 v[136:139], a[72:75], a[24:27], v[136:139]
    v_exp_f32_e32 v129, v129
    v_mfma_f32_16x16x32_bf16 v[136:139], a[76:79], a[28:31], v[136:139]
    ds_read_b64_tr_b16 a[112:113], v216 offset:32768
    ds_read_b128 a[136:139], v210 offset:24576
    v_mfma_f32_16x16x32_bf16 v[140:143], a[80:83], a[16:19], v[196:199]
    v_exp_f32_e32 v130, v130
    v_mfma_f32_16x16x32_bf16 v[140:143], a[84:87], a[20:23], v[140:143]
    ds_read_b128 a[140:143], v211 offset:24576
    v_cvt_pk_bf16_f32 v160, v128, v129
    v_mfma_f32_16x16x32_bf16 v[140:143], a[88:91], a[24:27], v[140:143]
    v_exp_f32_e32 v131, v131
    v_mfma_f32_16x16x32_bf16 v[140:143], a[92:95], a[28:31], v[140:143]
    ds_read_b64_tr_b16 a[114:115], v216 offset:36864
    ds_read_b128 a[144:147], v208 offset:28672
    v_mfma_f32_16x16x32_bf16 a[224:227], a[240:243], v[176:179], a[224:227]
    v_exp_f32_e32 v132, v132
    v_mfma_f32_16x16x32_bf16 v[0:3], a[160:163], v[176:179], v[0:3]
    ds_read_b64_tr_b16 a[116:117], v217 offset:32768
    v_cvt_pk_bf16_f32 v161, v130, v131
    v_mfma_f32_16x16x32_bf16 v[4:7], a[164:167], v[176:179], v[4:7]
    v_exp_f32_e32 v133, v133
    v_mfma_f32_16x16x32_bf16 v[8:11], a[168:171], v[176:179], v[8:11]
    ds_read_b128 a[148:151], v209 offset:28672
    ds_read_b64_tr_b16 a[118:119], v217 offset:36864
    v_mfma_f32_16x16x32_bf16 v[12:15], a[172:175], v[176:179], v[12:15]
    s_waitcnt lgkmcnt(5)
    v_exp_f32_e32 v134, v134
    v_mfma_f32_16x16x32_bf16 v[16:19], a[176:179], v[176:179], v[16:19]
    ds_read_b128 a[152:155], v210 offset:28672
    v_cvt_pk_bf16_f32 v162, v132, v133
    v_mfma_f32_16x16x32_bf16 v[20:23], a[180:183], v[176:179], v[20:23]
    v_exp_f32_e32 v135, v135
    v_mfma_f32_16x16x32_bf16 v[24:27], a[184:187], v[176:179], v[24:27]
    ds_read_b128 a[156:159], v211 offset:28672
    ds_read_b64_tr_b16 a[120:121], v218 offset:32768
    v_mfma_f32_16x16x32_bf16 v[28:31], a[188:191], v[176:179], v[28:31]
    ds_read_b64_tr_b16 a[122:123], v218 offset:36864
    ds_read_b64_tr_b16 a[124:125], v219 offset:32768
    v_mfma_f32_16x16x32_bf16 a[228:231], a[240:243], v[180:183], a[228:231]
    v_exp_f32_e32 v136, v136
    v_mfma_f32_16x16x32_bf16 v[32:35], a[160:163], v[180:183], v[32:35]
    ds_read_b64_tr_b16 a[126:127], v219 offset:36864
    v_cvt_pk_bf16_f32 v163, v134, v135
    v_mfma_f32_16x16x32_bf16 v[36:39], a[164:167], v[180:183], v[36:39]
    v_exp_f32_e32 v137, v137
    v_mfma_f32_16x16x32_bf16 v[40:43], a[168:171], v[180:183], v[40:43]
    v_exp_f32_e32 v138, v138
    v_mfma_f32_16x16x32_bf16 v[44:47], a[172:175], v[180:183], v[44:47]
    v_cvt_pk_bf16_f32 v164, v136, v137
    v_mfma_f32_16x16x32_bf16 v[48:51], a[176:179], v[180:183], v[48:51]
    v_exp_f32_e32 v139, v139
    v_mfma_f32_16x16x32_bf16 v[52:55], a[180:183], v[180:183], v[52:55]
    v_exp_f32_e32 v140, v140
    v_mfma_f32_16x16x32_bf16 v[56:59], a[184:187], v[180:183], v[56:59]
    s_waitcnt vmcnt(0)
    v_cvt_pk_bf16_f32 v165, v138, v139
    v_mfma_f32_16x16x32_bf16 v[60:63], a[188:191], v[180:183], v[60:63]
    v_exp_f32_e32 v141, v141
    v_mfma_f32_16x16x32_bf16 v[128:131], a[128:131], a[0:3], v[192:195]
    s_barrier
    v_mfma_f32_16x16x32_bf16 v[128:131], a[132:135], a[4:7], v[128:131]
    ds_read_b64_tr_b16 a[160:161], v212
    ds_read_b64_tr_b16 a[162:163], v212 offset:4096
    v_mfma_f32_16x16x32_bf16 v[128:131], a[136:139], a[8:11], v[128:131]
    ds_read_b64_tr_b16 a[164:165], v213
    ds_read_b64_tr_b16 a[166:167], v213 offset:4096
    v_mfma_f32_16x16x32_bf16 v[128:131], a[140:143], a[12:15], v[128:131]
    s_waitcnt lgkmcnt(4)
    v_exp_f32_e32 v142, v142
    v_mfma_f32_16x16x32_bf16 v[132:135], a[144:147], a[0:3], v[192:195]
    ds_read_b64_tr_b16 a[168:169], v214
    v_cvt_pk_bf16_f32 v166, v140, v141
    v_mfma_f32_16x16x32_bf16 v[132:135], a[148:151], a[4:7], v[132:135]
    v_exp_f32_e32 v143, v143
    v_mfma_f32_16x16x32_bf16 v[132:135], a[152:155], a[8:11], v[132:135]
    ds_read_b64_tr_b16 a[170:171], v214 offset:4096
    ds_read_b64_tr_b16 a[172:173], v215
    v_mfma_f32_16x16x32_bf16 v[132:135], a[156:159], a[12:15], v[132:135]
    ds_read_b64_tr_b16 a[174:175], v215 offset:4096
    ds_read_b64_tr_b16 a[176:177], v216
    v_mfma_f32_16x16x32_bf16 v[136:139], a[128:131], a[16:19], v[196:199]
    v_exp_f32_e32 v128, v128
    v_mfma_f32_16x16x32_bf16 v[136:139], a[132:135], a[20:23], v[136:139]
    ds_read_b64_tr_b16 a[178:179], v216 offset:4096
    v_cvt_pk_bf16_f32 v167, v142, v143
    v_mfma_f32_16x16x32_bf16 v[136:139], a[136:139], a[24:27], v[136:139]
    v_exp_f32_e32 v129, v129
    v_mfma_f32_16x16x32_bf16 v[136:139], a[140:143], a[28:31], v[136:139]
    ds_read_b64_tr_b16 a[180:181], v217
    ds_read_b64_tr_b16 a[182:183], v217 offset:4096
    v_mfma_f32_16x16x32_bf16 v[140:143], a[144:147], a[16:19], v[196:199]
    v_exp_f32_e32 v130, v130
    v_mfma_f32_16x16x32_bf16 v[140:143], a[148:151], a[20:23], v[140:143]
    ds_read_b64_tr_b16 a[184:185], v218
    v_cvt_pk_bf16_f32 v176, v128, v129
    v_mfma_f32_16x16x32_bf16 v[140:143], a[152:155], a[24:27], v[140:143]
    v_exp_f32_e32 v131, v131
    v_mfma_f32_16x16x32_bf16 v[140:143], a[156:159], a[28:31], v[140:143]
    ds_read_b64_tr_b16 a[186:187], v218 offset:4096
    ds_read_b64_tr_b16 a[188:189], v219
    v_mfma_f32_16x16x32_bf16 a[224:227], a[240:243], v[160:163], a[224:227]
    v_exp_f32_e32 v132, v132
    v_mfma_f32_16x16x32_bf16 v[0:3], a[96:99], v[160:163], v[0:3]
    ds_read_b64_tr_b16 a[190:191], v219 offset:4096
    v_cvt_pk_bf16_f32 v177, v130, v131
    v_mfma_f32_16x16x32_bf16 v[4:7], a[100:103], v[160:163], v[4:7]
    v_exp_f32_e32 v133, v133
    v_mfma_f32_16x16x32_bf16 v[8:11], a[104:107], v[160:163], v[8:11]
    v_exp_f32_e32 v134, v134
    v_mfma_f32_16x16x32_bf16 v[12:15], a[108:111], v[160:163], v[12:15]
    v_cvt_pk_bf16_f32 v178, v132, v133
    v_mfma_f32_16x16x32_bf16 v[16:19], a[112:115], v[160:163], v[16:19]
    v_exp_f32_e32 v135, v135
    v_mfma_f32_16x16x32_bf16 v[20:23], a[116:119], v[160:163], v[20:23]
    v_mfma_f32_16x16x32_bf16 v[24:27], a[120:123], v[160:163], v[24:27]
    v_exp_f32_e32 v136, v136
    v_mfma_f32_16x16x32_bf16 v[28:31], a[124:127], v[160:163], v[28:31]
    v_cvt_pk_bf16_f32 v179, v134, v135
    v_mfma_f32_16x16x32_bf16 a[228:231], a[240:243], v[164:167], a[228:231]
    v_exp_f32_e32 v137, v137
    v_mfma_f32_16x16x32_bf16 v[32:35], a[96:99], v[164:167], v[32:35]
    v_mfma_f32_16x16x32_bf16 v[36:39], a[100:103], v[164:167], v[36:39]
    v_exp_f32_e32 v138, v138
    v_mfma_f32_16x16x32_bf16 v[40:43], a[104:107], v[164:167], v[40:43]
    v_cvt_pk_bf16_f32 v180, v136, v137
    v_mfma_f32_16x16x32_bf16 v[44:47], a[108:111], v[164:167], v[44:47]
    v_exp_f32_e32 v139, v139
    v_mfma_f32_16x16x32_bf16 v[48:51], a[112:115], v[164:167], v[48:51]
    v_mfma_f32_16x16x32_bf16 v[52:55], a[116:119], v[164:167], v[52:55]
    s_waitcnt lgkmcnt(0)
    v_exp_f32_e32 v140, v140
    v_mfma_f32_16x16x32_bf16 v[56:59], a[120:123], v[164:167], v[56:59]
    v_cvt_pk_bf16_f32 v181, v138, v139
    v_mfma_f32_16x16x32_bf16 v[60:63], a[124:127], v[164:167], v[60:63]
    v_exp_f32_e32 v141, v141
    v_mfma_f32_16x16x32_bf16 a[224:227], a[240:243], v[176:179], a[224:227]
    v_mfma_f32_16x16x32_bf16 v[0:3], a[160:163], v[176:179], v[0:3]
    ds_read_b128 a[128:131], v208 offset:8192
    ds_read_b64_tr_b16 a[96:97], v212 offset:16384
    ds_read_b64_tr_b16 a[98:99], v212 offset:20480
    v_mfma_f32_16x16x32_bf16 v[4:7], a[164:167], v[176:179], v[4:7]
    ds_read_b128 a[132:135], v209 offset:8192
    ds_read_b64_tr_b16 a[100:101], v213 offset:16384
    v_mfma_f32_16x16x32_bf16 v[8:11], a[168:171], v[176:179], v[8:11]
    ds_read_b128 a[136:139], v210 offset:8192
    ds_read_b64_tr_b16 a[102:103], v213 offset:20480
    v_exp_f32_e32 v142, v142
    v_mfma_f32_16x16x32_bf16 v[12:15], a[172:175], v[176:179], v[12:15]
    ds_read_b128 a[140:143], v211 offset:8192
    ds_read_b64_tr_b16 a[104:105], v214 offset:16384
    v_accvgpr_read_b32 v224, a224
    v_rcp_f32_e32 v228, v224
    v_cvt_pk_bf16_f32 v182, v140, v141
    v_mfma_f32_16x16x32_bf16 v[16:19], a[176:179], v[176:179], v[16:19]
    ds_read_b128 a[144:147], v208 offset:12288
    ds_read_b64_tr_b16 a[106:107], v214 offset:20480
    v_cmp_nge_f32_e64 s[88:89], v237, v224
    v_exp_f32_e32 v143, v143
    v_mfma_f32_16x16x32_bf16 v[20:23], a[180:183], v[176:179], v[20:23]
    s_mov_b64 vcc, s[88:89]
    ds_read_b128 a[148:151], v209 offset:12288
    ds_read_b64_tr_b16 a[108:109], v215 offset:16384
    v_mul_f32_e32 v0, v228, v0
    v_mul_f32_e32 v1, v228, v1
    v_mul_f32_e32 v2, v228, v2
    v_mfma_f32_16x16x32_bf16 v[24:27], a[184:187], v[176:179], v[24:27]
    ds_read_b128 a[152:155], v210 offset:12288
    ds_read_b64_tr_b16 a[110:111], v215 offset:20480
    v_mul_f32_e32 v3, v228, v3
    v_cvt_pk_bf16_f32 v0, v0, v1
    v_cvt_pk_bf16_f32 v1, v2, v3
    v_cvt_pk_bf16_f32 v183, v142, v143
    v_mfma_f32_16x16x32_bf16 v[28:31], a[188:191], v[176:179], v[28:31]
    ds_read_b128 a[156:159], v211 offset:12288
    ds_read_b64_tr_b16 a[112:113], v216 offset:16384
    v_mfma_f32_16x16x32_bf16 a[228:231], a[240:243], v[180:183], a[228:231]
    ds_write_b64 v244, v[0:1]
    ds_read_b64_tr_b16 a[114:115], v216 offset:20480
    v_mul_f32_e32 v4, v228, v4
    v_mul_f32_e32 v5, v228, v5
    v_mul_f32_e32 v6, v228, v6
    v_mul_f32_e32 v7, v228, v7
    v_cvt_pk_bf16_f32 v4, v4, v5
    v_cvt_pk_bf16_f32 v5, v6, v7
    v_mfma_f32_16x16x32_bf16 v[32:35], a[160:163], v[180:183], v[32:35]
    ds_read_b64_tr_b16 a[116:117], v217 offset:16384
    ds_write_b64 v245, v[4:5]
    v_mfma_f32_16x16x32_bf16 v[36:39], a[164:167], v[180:183], v[36:39]
    ds_read_b64_tr_b16 a[118:119], v217 offset:20480
    v_mul_f32_e32 v8, v228, v8
    v_mul_f32_e32 v9, v228, v9
    v_mul_f32_e32 v10, v228, v10
    v_mul_f32_e32 v11, v228, v11
    v_cvt_pk_bf16_f32 v8, v8, v9
    v_cvt_pk_bf16_f32 v9, v10, v11
    v_mfma_f32_16x16x32_bf16 v[40:43], a[168:171], v[180:183], v[40:43]
    ds_read_b64_tr_b16 a[120:121], v218 offset:16384
    ds_write_b64 v246, v[8:9]
    v_mfma_f32_16x16x32_bf16 v[44:47], a[172:175], v[180:183], v[44:47]
    ds_read_b64_tr_b16 a[122:123], v218 offset:20480
    v_mul_f32_e32 v12, v228, v12
    v_mul_f32_e32 v13, v228, v13
    v_mul_f32_e32 v14, v228, v14
    v_mul_f32_e32 v15, v228, v15
    v_cvt_pk_bf16_f32 v12, v12, v13
    v_cvt_pk_bf16_f32 v13, v14, v15
    v_mfma_f32_16x16x32_bf16 v[48:51], a[176:179], v[180:183], v[48:51]
    ds_read_b64_tr_b16 a[124:125], v219 offset:16384
    ds_write_b64 v247, v[12:13]
    v_mfma_f32_16x16x32_bf16 v[52:55], a[180:183], v[180:183], v[52:55]
    ds_read_b64_tr_b16 a[126:127], v219 offset:20480
    v_mul_f32_e32 v16, v228, v16
    v_mul_f32_e32 v17, v228, v17
    v_mul_f32_e32 v18, v228, v18
    v_mul_f32_e32 v19, v228, v19
    v_cvt_pk_bf16_f32 v16, v16, v17
    v_cvt_pk_bf16_f32 v17, v18, v19
    v_mfma_f32_16x16x32_bf16 v[56:59], a[184:187], v[180:183], v[56:59]
    ds_write_b64 v244, v[16:17] offset:128
    v_mul_f32_e32 v20, v228, v20
    v_mfma_f32_16x16x32_bf16 v[60:63], a[188:191], v[180:183], v[60:63]
    s_waitcnt lgkmcnt(7)
    v_mul_f32_e32 v21, v228, v21
    v_mul_f32_e32 v22, v228, v22
    v_mul_f32_e32 v23, v228, v23
    v_cvt_pk_bf16_f32 v20, v20, v21
    v_cvt_pk_bf16_f32 v21, v22, v23
    v_mfma_f32_16x16x32_bf16 v[144:147], a[128:131], a[32:35], v[200:203]
    ds_write_b64 v245, v[20:21] offset:128
    v_mul_f32_e32 v24, v228, v24
    v_mfma_f32_16x16x32_bf16 v[144:147], a[132:135], a[36:39], v[144:147]
    ds_read_b64_tr_b16 a[160:161], v212 offset:24576
    v_mul_f32_e32 v25, v228, v25
    v_mul_f32_e32 v26, v228, v26
    v_mul_f32_e32 v27, v228, v27
    v_cvt_pk_bf16_f32 v24, v24, v25
    v_cvt_pk_bf16_f32 v25, v26, v27
    v_mfma_f32_16x16x32_bf16 v[144:147], a[136:139], a[40:43], v[144:147]
    ds_read_b64_tr_b16 a[162:163], v212 offset:28672
    ds_write_b64 v246, v[24:25] offset:128
    v_mfma_f32_16x16x32_bf16 v[144:147], a[140:143], a[44:47], v[144:147]
    v_mul_f32_e32 v28, v228, v28
    v_mul_f32_e32 v29, v228, v29
    v_mul_f32_e32 v30, v228, v30
    v_mul_f32_e32 v31, v228, v31
    v_cvt_pk_bf16_f32 v28, v28, v29
    v_cvt_pk_bf16_f32 v29, v30, v31
    v_mfma_f32_16x16x32_bf16 v[148:151], a[144:147], a[32:35], v[200:203]
    ds_read_b64_tr_b16 a[164:165], v213 offset:24576
    ds_write_b64 v247, v[28:29] offset:128
    v_mfma_f32_16x16x32_bf16 v[148:151], a[148:151], a[36:39], v[148:151]
    ds_read_b128 a[192:195], v241
    ds_read_b128 a[196:199], v242 offset:1024
    v_mfma_f32_16x16x32_bf16 v[148:151], a[152:155], a[40:43], v[148:151]
    ds_read_b128 a[200:203], v241 offset:2048
    ds_read_b128 a[204:207], v242 offset:3072
    ds_read_b64_tr_b16 a[166:167], v213 offset:28672
    v_accvgpr_read_b32 v225, a228
    v_rcp_f32_e32 v229, v225
    v_cmp_nge_f32_e64 s[88:89], v237, v225
    v_mfma_f32_16x16x32_bf16 v[148:151], a[156:159], a[44:47], v[148:151]
    s_or_b64 vcc, vcc, s[88:89]
    v_mul_f32_e32 v32, v229, v32
    v_mul_f32_e32 v33, v229, v33
    v_mul_f32_e32 v34, v229, v34
    v_mfma_f32_16x16x32_bf16 v[152:155], a[128:131], a[48:51], v[204:207]
    ds_read_b64_tr_b16 a[168:169], v214 offset:24576
    v_mul_f32_e32 v35, v229, v35
    v_cvt_pk_bf16_f32 v32, v32, v33
    v_cvt_pk_bf16_f32 v33, v34, v35
    v_exp_f32_e32 v144, v144
    v_mfma_f32_16x16x32_bf16 v[152:155], a[132:135], a[52:55], v[152:155]
    ds_write_b64 v244, v[32:33] offset:4096
    ds_read_b64_tr_b16 a[170:171], v214 offset:28672
    v_mfma_f32_16x16x32_bf16 v[152:155], a[136:139], a[56:59], v[152:155]
    v_mul_f32_e32 v36, v229, v36
    v_mul_f32_e32 v37, v229, v37
    v_mul_f32_e32 v38, v229, v38
    v_mul_f32_e32 v39, v229, v39
    v_cvt_pk_bf16_f32 v36, v36, v37
    v_cvt_pk_bf16_f32 v37, v38, v39
    v_exp_f32_e32 v145, v145
    v_mfma_f32_16x16x32_bf16 v[152:155], a[140:143], a[60:63], v[152:155]
    ds_write_b64 v245, v[36:37] offset:4096
    ds_read_b64_tr_b16 a[172:173], v215 offset:24576
    v_mfma_f32_16x16x32_bf16 v[156:159], a[144:147], a[48:51], v[204:207]
    v_mul_f32_e32 v40, v229, v40
    v_mul_f32_e32 v41, v229, v41
    v_mul_f32_e32 v42, v229, v42
    v_mul_f32_e32 v43, v229, v43
    v_cvt_pk_bf16_f32 v40, v40, v41
    v_cvt_pk_bf16_f32 v41, v42, v43
    v_exp_f32_e32 v146, v146
    v_mfma_f32_16x16x32_bf16 v[156:159], a[148:151], a[52:55], v[156:159]
    ds_write_b64 v246, v[40:41] offset:4096
    v_cvt_pk_bf16_f32 v184, v144, v145
    v_mfma_f32_16x16x32_bf16 v[156:159], a[152:155], a[56:59], v[156:159]
    ds_read_b128 a[64:67], v208 offset:16384
    ds_read_b64_tr_b16 a[174:175], v215 offset:28672
    v_mul_f32_e32 v44, v229, v44
    v_mul_f32_e32 v45, v229, v45
    v_mul_f32_e32 v46, v229, v46
    v_mul_f32_e32 v47, v229, v47
    v_cvt_pk_bf16_f32 v44, v44, v45
    v_cvt_pk_bf16_f32 v45, v46, v47
    v_exp_f32_e32 v147, v147
    v_mfma_f32_16x16x32_bf16 v[156:159], a[156:159], a[60:63], v[156:159]
    ds_read_b128 a[68:71], v209 offset:16384
    s_waitcnt lgkmcnt(13)
    buffer_store_dwordx4 a[192:195], v243, s[24:27], s32 offen sc1
    v_mfma_f32_16x16x32_bf16 a[232:235], a[240:243], v[168:171], a[232:235]
    ds_write_b64 v247, v[44:45] offset:4096
    ds_read_b64_tr_b16 a[176:177], v216 offset:24576
    v_mul_f32_e32 v48, v229, v48
    v_mul_f32_e32 v49, v229, v49
    v_mul_f32_e32 v50, v229, v50
    v_mul_f32_e32 v51, v229, v51
    v_cvt_pk_bf16_f32 v48, v48, v49
    v_cvt_pk_bf16_f32 v49, v50, v51
    v_exp_f32_e32 v148, v148
    v_mfma_f32_16x16x32_bf16 v[64:67], a[96:99], v[168:171], v[64:67]
    ds_read_b128 a[72:75], v210 offset:16384
    s_waitcnt lgkmcnt(15)
    buffer_store_dwordx4 a[196:199], v243, s[24:27], s32 offen offset:1024 sc1
    v_cvt_pk_bf16_f32 v185, v146, v147
    v_mfma_f32_16x16x32_bf16 v[68:71], a[100:103], v[168:171], v[68:71]
    ds_write_b64 v244, v[48:49] offset:4224
    ds_read_b128 a[76:79], v211 offset:16384
    ds_read_b64_tr_b16 a[178:179], v216 offset:28672
    v_mul_f32_e32 v52, v229, v52
    v_mul_f32_e32 v53, v229, v53
    v_mul_f32_e32 v54, v229, v54
    v_mul_f32_e32 v55, v229, v55
    v_cvt_pk_bf16_f32 v52, v52, v53
    v_cvt_pk_bf16_f32 v53, v54, v55
    v_exp_f32_e32 v149, v149
    v_mfma_f32_16x16x32_bf16 v[72:75], a[104:107], v[168:171], v[72:75]
    s_waitcnt lgkmcnt(15)
    buffer_store_dwordx4 a[200:203], v243, s[24:27], s32 offen offset:2048 sc1
    ds_write_b64 v245, v[52:53] offset:4224
    v_mfma_f32_16x16x32_bf16 v[76:79], a[108:111], v[168:171], v[76:79]
    ds_read_b128 a[80:83], v208 offset:20480
    ds_read_b64_tr_b16 a[180:181], v217 offset:24576
    v_mul_f32_e32 v56, v229, v56
    v_mul_f32_e32 v57, v229, v57
    v_mul_f32_e32 v58, v229, v58
    v_mul_f32_e32 v59, v229, v59
    v_cvt_pk_bf16_f32 v56, v56, v57
    v_cvt_pk_bf16_f32 v57, v58, v59
    v_exp_f32_e32 v150, v150
    v_mfma_f32_16x16x32_bf16 v[80:83], a[112:115], v[168:171], v[80:83]
    ds_read_b128 a[84:87], v209 offset:20480
    s_waitcnt lgkmcnt(15)
    buffer_store_dwordx4 a[204:207], v243, s[24:27], s32 offen offset:3072 sc1
    v_cvt_pk_bf16_f32 v186, v148, v149
    v_mfma_f32_16x16x32_bf16 v[84:87], a[116:119], v[168:171], v[84:87]
    ds_write_b64 v246, v[56:57] offset:4224
    ds_read_b64_tr_b16 a[182:183], v217 offset:28672
    v_mul_f32_e32 v60, v229, v60
    v_mul_f32_e32 v61, v229, v61
    v_mul_f32_e32 v62, v229, v62
    v_mul_f32_e32 v63, v229, v63
    v_cvt_pk_bf16_f32 v60, v60, v61
    v_cvt_pk_bf16_f32 v61, v62, v63
    v_exp_f32_e32 v151, v151
    v_mfma_f32_16x16x32_bf16 v[88:91], a[120:123], v[168:171], v[88:91]
    ds_read_b128 a[88:91], v210 offset:20480
    ds_write_b64 v247, v[60:61] offset:4224
    v_mfma_f32_16x16x32_bf16 v[92:95], a[124:127], v[168:171], v[92:95]
    ds_read_b128 a[92:95], v211 offset:20480
    ds_read_b64_tr_b16 a[184:185], v218 offset:24576
    v_mfma_f32_16x16x32_bf16 a[236:239], a[240:243], v[172:175], a[236:239]
    ds_read_b128 a[208:211], v241 offset:4096
    ds_read_b128 a[212:215], v242 offset:5120
    ds_read_b128 a[216:219], v241 offset:6144
    ds_read_b128 a[220:223], v242 offset:7168
    v_exp_f32_e32 v152, v152
    v_mfma_f32_16x16x32_bf16 v[96:99], a[96:99], v[172:175], v[96:99]
    ds_read_b64_tr_b16 a[186:187], v218 offset:28672
    v_cvt_pk_bf16_f32 v187, v150, v151
    v_mfma_f32_16x16x32_bf16 v[100:103], a[100:103], v[172:175], v[100:103]
    v_exp_f32_e32 v153, v153
    v_mfma_f32_16x16x32_bf16 v[104:107], a[104:107], v[172:175], v[104:107]
    ds_read_b64_tr_b16 a[188:189], v219 offset:24576
    ds_read_b64_tr_b16 a[190:191], v219 offset:28672
    v_mfma_f32_16x16x32_bf16 v[108:111], a[108:111], v[172:175], v[108:111]
    v_exp_f32_e32 v154, v154
    v_mfma_f32_16x16x32_bf16 v[112:115], a[112:115], v[172:175], v[112:115]
    s_waitcnt lgkmcnt(7)
    v_cvt_pk_bf16_f32 v188, v152, v153
    v_exp_f32_e32 v155, v155
    v_mfma_f32_16x16x32_bf16 v[116:119], a[116:119], v[172:175], v[116:119]
    v_exp_f32_e32 v156, v156
    v_mfma_f32_16x16x32_bf16 v[120:123], a[120:123], v[172:175], v[120:123]
    s_waitcnt lgkmcnt(6)
    buffer_store_dwordx4 a[208:211], v243, s[24:27], s33 offen sc1
    s_waitcnt lgkmcnt(5)
    buffer_store_dwordx4 a[212:215], v243, s[24:27], s33 offen offset:1024 sc1
    v_mfma_f32_16x16x32_bf16 v[124:127], a[124:127], v[172:175], v[124:127]
    s_waitcnt lgkmcnt(4)
    buffer_store_dwordx4 a[216:219], v243, s[24:27], s33 offen offset:2048 sc1
    s_waitcnt lgkmcnt(3)
    buffer_store_dwordx4 a[220:223], v243, s[24:27], s33 offen offset:3072 sc1
    v_mfma_f32_16x16x32_bf16 v[144:147], a[64:67], a[32:35], v[200:203]
    v_cvt_pk_bf16_f32 v189, v154, v155
    v_exp_f32_e32 v157, v157
    v_mfma_f32_16x16x32_bf16 v[144:147], a[68:71], a[36:39], v[144:147]
    ds_read_b64_tr_b16 a[96:97], v212 offset:32768
    ds_read_b64_tr_b16 a[98:99], v212 offset:36864
    v_mfma_f32_16x16x32_bf16 v[144:147], a[72:75], a[40:43], v[144:147]
    ds_read_b64_tr_b16 a[100:101], v213 offset:32768
    ds_read_b64_tr_b16 a[102:103], v213 offset:36864
    v_mfma_f32_16x16x32_bf16 v[144:147], a[76:79], a[44:47], v[144:147]
    v_exp_f32_e32 v158, v158
    v_mfma_f32_16x16x32_bf16 v[148:151], a[80:83], a[32:35], v[200:203]
    ds_read_b64_tr_b16 a[104:105], v214 offset:32768
    v_cvt_pk_bf16_f32 v190, v156, v157
    v_mfma_f32_16x16x32_bf16 v[148:151], a[84:87], a[36:39], v[148:151]
    v_exp_f32_e32 v159, v159
    v_mfma_f32_16x16x32_bf16 v[148:151], a[88:91], a[40:43], v[148:151]
    ds_read_b64_tr_b16 a[106:107], v214 offset:36864
    ds_read_b64_tr_b16 a[108:109], v215 offset:32768
    v_mfma_f32_16x16x32_bf16 v[148:151], a[92:95], a[44:47], v[148:151]
    ds_read_b128 a[128:131], v208 offset:24576
    ds_read_b64_tr_b16 a[110:111], v215 offset:36864
    v_mfma_f32_16x16x32_bf16 v[152:155], a[64:67], a[48:51], v[204:207]
    v_exp_f32_e32 v144, v144
    v_mfma_f32_16x16x32_bf16 v[152:155], a[68:71], a[52:55], v[152:155]
    ds_read_b128 a[132:135], v209 offset:24576
    v_cvt_pk_bf16_f32 v191, v158, v159
    v_mfma_f32_16x16x32_bf16 v[152:155], a[72:75], a[56:59], v[152:155]
    v_exp_f32_e32 v145, v145
    v_mfma_f32_16x16x32_bf16 v[152:155], a[76:79], a[60:63], v[152:155]
    ds_read_b64_tr_b16 a[112:113], v216 offset:32768
    ds_read_b128 a[136:139], v210 offset:24576
    v_mfma_f32_16x16x32_bf16 v[156:159], a[80:83], a[48:51], v[204:207]
    v_exp_f32_e32 v146, v146
    v_mfma_f32_16x16x32_bf16 v[156:159], a[84:87], a[52:55], v[156:159]
    ds_read_b128 a[140:143], v211 offset:24576
    v_cvt_pk_bf16_f32 v168, v144, v145
    v_mfma_f32_16x16x32_bf16 v[156:159], a[88:91], a[56:59], v[156:159]
    v_exp_f32_e32 v147, v147
    v_mfma_f32_16x16x32_bf16 v[156:159], a[92:95], a[60:63], v[156:159]
    ds_read_b64_tr_b16 a[114:115], v216 offset:36864
    ds_read_b128 a[144:147], v208 offset:28672
    v_mfma_f32_16x16x32_bf16 a[232:235], a[240:243], v[184:187], a[232:235]
    v_exp_f32_e32 v148, v148
    v_mfma_f32_16x16x32_bf16 v[64:67], a[160:163], v[184:187], v[64:67]
    ds_read_b64_tr_b16 a[116:117], v217 offset:32768
    v_cvt_pk_bf16_f32 v169, v146, v147
    v_mfma_f32_16x16x32_bf16 v[68:71], a[164:167], v[184:187], v[68:71]
    v_exp_f32_e32 v149, v149
    v_mfma_f32_16x16x32_bf16 v[72:75], a[168:171], v[184:187], v[72:75]
    ds_read_b128 a[148:151], v209 offset:28672
    ds_read_b64_tr_b16 a[118:119], v217 offset:36864
    v_mfma_f32_16x16x32_bf16 v[76:79], a[172:175], v[184:187], v[76:79]
    s_waitcnt lgkmcnt(5)
    v_exp_f32_e32 v150, v150
    v_mfma_f32_16x16x32_bf16 v[80:83], a[176:179], v[184:187], v[80:83]
    ds_read_b128 a[152:155], v210 offset:28672
    v_cvt_pk_bf16_f32 v170, v148, v149
    v_mfma_f32_16x16x32_bf16 v[84:87], a[180:183], v[184:187], v[84:87]
    v_exp_f32_e32 v151, v151
    v_mfma_f32_16x16x32_bf16 v[88:91], a[184:187], v[184:187], v[88:91]
    ds_read_b128 a[156:159], v211 offset:28672
    ds_read_b64_tr_b16 a[120:121], v218 offset:32768
    v_mfma_f32_16x16x32_bf16 v[92:95], a[188:191], v[184:187], v[92:95]
    ds_read_b64_tr_b16 a[122:123], v218 offset:36864
    ds_read_b64_tr_b16 a[124:125], v219 offset:32768
    v_mfma_f32_16x16x32_bf16 a[236:239], a[240:243], v[188:191], a[236:239]
    v_exp_f32_e32 v152, v152
    v_mfma_f32_16x16x32_bf16 v[96:99], a[160:163], v[188:191], v[96:99]
    ds_read_b64_tr_b16 a[126:127], v219 offset:36864
    v_cvt_pk_bf16_f32 v171, v150, v151
    v_mfma_f32_16x16x32_bf16 v[100:103], a[164:167], v[188:191], v[100:103]
    v_exp_f32_e32 v153, v153
    v_mfma_f32_16x16x32_bf16 v[104:107], a[168:171], v[188:191], v[104:107]
    v_exp_f32_e32 v154, v154
    v_mfma_f32_16x16x32_bf16 v[108:111], a[172:175], v[188:191], v[108:111]
    v_cvt_pk_bf16_f32 v172, v152, v153
    v_mfma_f32_16x16x32_bf16 v[112:115], a[176:179], v[188:191], v[112:115]
    v_exp_f32_e32 v155, v155
    v_mfma_f32_16x16x32_bf16 v[116:119], a[180:183], v[188:191], v[116:119]
    v_exp_f32_e32 v156, v156
    v_mfma_f32_16x16x32_bf16 v[120:123], a[184:187], v[188:191], v[120:123]
    v_cvt_pk_bf16_f32 v173, v154, v155
    v_mfma_f32_16x16x32_bf16 v[124:127], a[188:191], v[188:191], v[124:127]
    v_exp_f32_e32 v157, v157
    v_mfma_f32_16x16x32_bf16 v[144:147], a[128:131], a[32:35], v[200:203]
    s_waitcnt lgkmcnt(0)
    v_mfma_f32_16x16x32_bf16 v[144:147], a[132:135], a[36:39], v[144:147]
    ds_read_b64_tr_b16 a[160:161], v212
    ds_read_b64_tr_b16 a[162:163], v212 offset:4096
    v_mfma_f32_16x16x32_bf16 v[144:147], a[136:139], a[40:43], v[144:147]
    ds_read_b64_tr_b16 a[164:165], v213
    ds_read_b64_tr_b16 a[166:167], v213 offset:4096
    v_mfma_f32_16x16x32_bf16 v[144:147], a[140:143], a[44:47], v[144:147]
    v_exp_f32_e32 v158, v158
    v_mfma_f32_16x16x32_bf16 v[148:151], a[144:147], a[32:35], v[200:203]
    ds_read_b64_tr_b16 a[168:169], v214
    v_cvt_pk_bf16_f32 v174, v156, v157
    v_mfma_f32_16x16x32_bf16 v[148:151], a[148:151], a[36:39], v[148:151]
    v_exp_f32_e32 v159, v159
    v_mfma_f32_16x16x32_bf16 v[148:151], a[152:155], a[40:43], v[148:151]
    ds_read_b64_tr_b16 a[170:171], v214 offset:4096
    ds_read_b64_tr_b16 a[172:173], v215
    v_mfma_f32_16x16x32_bf16 v[148:151], a[156:159], a[44:47], v[148:151]
    ds_read_b64_tr_b16 a[174:175], v215 offset:4096
    ds_read_b64_tr_b16 a[176:177], v216
    v_mfma_f32_16x16x32_bf16 v[152:155], a[128:131], a[48:51], v[204:207]
    v_exp_f32_e32 v144, v144
    v_mfma_f32_16x16x32_bf16 v[152:155], a[132:135], a[52:55], v[152:155]
    ds_read_b64_tr_b16 a[178:179], v216 offset:4096
    v_cvt_pk_bf16_f32 v175, v158, v159
    v_mfma_f32_16x16x32_bf16 v[152:155], a[136:139], a[56:59], v[152:155]
    v_exp_f32_e32 v145, v145
    v_mfma_f32_16x16x32_bf16 v[152:155], a[140:143], a[60:63], v[152:155]
    ds_read_b64_tr_b16 a[180:181], v217
    ds_read_b64_tr_b16 a[182:183], v217 offset:4096
    v_mfma_f32_16x16x32_bf16 v[156:159], a[144:147], a[48:51], v[204:207]
    v_exp_f32_e32 v146, v146
    v_mfma_f32_16x16x32_bf16 v[156:159], a[148:151], a[52:55], v[156:159]
    ds_read_b64_tr_b16 a[184:185], v218
    v_cvt_pk_bf16_f32 v184, v144, v145
    v_mfma_f32_16x16x32_bf16 v[156:159], a[152:155], a[56:59], v[156:159]
    v_exp_f32_e32 v147, v147
    v_mfma_f32_16x16x32_bf16 v[156:159], a[156:159], a[60:63], v[156:159]
    ds_read_b64_tr_b16 a[186:187], v218 offset:4096
    ds_read_b64_tr_b16 a[188:189], v219
    v_mfma_f32_16x16x32_bf16 a[232:235], a[240:243], v[168:171], a[232:235]
    v_exp_f32_e32 v148, v148
    v_mfma_f32_16x16x32_bf16 v[64:67], a[96:99], v[168:171], v[64:67]
    ds_read_b64_tr_b16 a[190:191], v219 offset:4096
    v_cvt_pk_bf16_f32 v185, v146, v147
    v_mfma_f32_16x16x32_bf16 v[68:71], a[100:103], v[168:171], v[68:71]
    v_exp_f32_e32 v149, v149
    v_mfma_f32_16x16x32_bf16 v[72:75], a[104:107], v[168:171], v[72:75]
    v_exp_f32_e32 v150, v150
    v_mfma_f32_16x16x32_bf16 v[76:79], a[108:111], v[168:171], v[76:79]
    v_cvt_pk_bf16_f32 v186, v148, v149
    v_mfma_f32_16x16x32_bf16 v[80:83], a[112:115], v[168:171], v[80:83]
    v_exp_f32_e32 v151, v151
    v_mfma_f32_16x16x32_bf16 v[84:87], a[116:119], v[168:171], v[84:87]
    v_mfma_f32_16x16x32_bf16 v[88:91], a[120:123], v[168:171], v[88:91]
    v_exp_f32_e32 v152, v152
    v_mfma_f32_16x16x32_bf16 v[92:95], a[124:127], v[168:171], v[92:95]
    v_cvt_pk_bf16_f32 v187, v150, v151
    v_mfma_f32_16x16x32_bf16 a[236:239], a[240:243], v[172:175], a[236:239]
    v_exp_f32_e32 v153, v153
    v_mfma_f32_16x16x32_bf16 v[96:99], a[96:99], v[172:175], v[96:99]
    v_mfma_f32_16x16x32_bf16 v[100:103], a[100:103], v[172:175], v[100:103]
    v_exp_f32_e32 v154, v154
    v_mfma_f32_16x16x32_bf16 v[104:107], a[104:107], v[172:175], v[104:107]
    v_cvt_pk_bf16_f32 v188, v152, v153
    v_mfma_f32_16x16x32_bf16 v[108:111], a[108:111], v[172:175], v[108:111]
    v_exp_f32_e32 v155, v155
    v_mfma_f32_16x16x32_bf16 v[112:115], a[112:115], v[172:175], v[112:115]
    v_mfma_f32_16x16x32_bf16 v[116:119], a[116:119], v[172:175], v[116:119]
    s_waitcnt lgkmcnt(0)
    v_exp_f32_e32 v156, v156
    v_mfma_f32_16x16x32_bf16 v[120:123], a[120:123], v[172:175], v[120:123]
    v_cvt_pk_bf16_f32 v189, v154, v155
    v_mfma_f32_16x16x32_bf16 v[124:127], a[124:127], v[172:175], v[124:127]
    v_exp_f32_e32 v157, v157
    v_mfma_f32_16x16x32_bf16 a[232:235], a[240:243], v[184:187], a[232:235]
    v_mfma_f32_16x16x32_bf16 v[64:67], a[160:163], v[184:187], v[64:67]
    v_exp_f32_e32 v158, v158
    v_mfma_f32_16x16x32_bf16 v[68:71], a[164:167], v[184:187], v[68:71]
    v_cvt_pk_bf16_f32 v190, v156, v157
    v_mfma_f32_16x16x32_bf16 v[72:75], a[168:171], v[184:187], v[72:75]
    v_exp_f32_e32 v159, v159
    v_mfma_f32_16x16x32_bf16 v[76:79], a[172:175], v[184:187], v[76:79]
    s_nop 0
    v_accvgpr_read_b32 v226, a232
    v_rcp_f32_e32 v230, v226
    v_mfma_f32_16x16x32_bf16 v[80:83], a[176:179], v[184:187], v[80:83]
    v_cmp_nge_f32_e64 s[88:89], v237, v226
    v_cvt_pk_bf16_f32 v191, v158, v159
    v_mfma_f32_16x16x32_bf16 v[84:87], a[180:183], v[184:187], v[84:87]
    s_or_b64 vcc, vcc, s[88:89]
    v_mul_f32_e32 v64, v230, v64
    v_mul_f32_e32 v65, v230, v65
    v_mul_f32_e32 v66, v230, v66
    v_mfma_f32_16x16x32_bf16 v[88:91], a[184:187], v[184:187], v[88:91]
    v_mul_f32_e32 v67, v230, v67
    v_cvt_pk_bf16_f32 v64, v64, v65
    v_cvt_pk_bf16_f32 v65, v66, v67
    v_mfma_f32_16x16x32_bf16 v[92:95], a[188:191], v[184:187], v[92:95]
    ds_write_b64 v244, v[64:65] offset:8192
    v_mul_f32_e32 v68, v230, v68
    v_mfma_f32_16x16x32_bf16 a[236:239], a[240:243], v[188:191], a[236:239]
    v_mul_f32_e32 v69, v230, v69
    v_mul_f32_e32 v70, v230, v70
    v_mul_f32_e32 v71, v230, v71
    v_cvt_pk_bf16_f32 v68, v68, v69
    v_cvt_pk_bf16_f32 v69, v70, v71
    v_mfma_f32_16x16x32_bf16 v[96:99], a[160:163], v[188:191], v[96:99]
    ds_write_b64 v245, v[68:69] offset:8192
    v_mul_f32_e32 v72, v230, v72
    v_mfma_f32_16x16x32_bf16 v[100:103], a[164:167], v[188:191], v[100:103]
    v_mul_f32_e32 v73, v230, v73
    v_mul_f32_e32 v74, v230, v74
    v_mul_f32_e32 v75, v230, v75
    v_cvt_pk_bf16_f32 v72, v72, v73
    v_cvt_pk_bf16_f32 v73, v74, v75
    v_mfma_f32_16x16x32_bf16 v[104:107], a[168:171], v[188:191], v[104:107]
    ds_write_b64 v246, v[72:73] offset:8192
    v_mul_f32_e32 v76, v230, v76
    v_mfma_f32_16x16x32_bf16 v[108:111], a[172:175], v[188:191], v[108:111]
    v_mul_f32_e32 v77, v230, v77
    v_mul_f32_e32 v78, v230, v78
    v_mul_f32_e32 v79, v230, v79
    v_cvt_pk_bf16_f32 v76, v76, v77
    v_cvt_pk_bf16_f32 v77, v78, v79
    v_mfma_f32_16x16x32_bf16 v[112:115], a[176:179], v[188:191], v[112:115]
    ds_write_b64 v247, v[76:77] offset:8192
    v_mul_f32_e32 v80, v230, v80
    v_mfma_f32_16x16x32_bf16 v[116:119], a[180:183], v[188:191], v[116:119]
    v_mul_f32_e32 v81, v230, v81
    v_mul_f32_e32 v82, v230, v82
    v_mul_f32_e32 v83, v230, v83
    v_cvt_pk_bf16_f32 v80, v80, v81
    v_cvt_pk_bf16_f32 v81, v82, v83
    v_mfma_f32_16x16x32_bf16 v[120:123], a[184:187], v[188:191], v[120:123]
    ds_write_b64 v244, v[80:81] offset:8320
    v_mul_f32_e32 v84, v230, v84
    v_mfma_f32_16x16x32_bf16 v[124:127], a[188:191], v[188:191], v[124:127]
    v_mul_f32_e32 v85, v230, v85
    v_mul_f32_e32 v86, v230, v86
    v_mul_f32_e32 v87, v230, v87
    v_cvt_pk_bf16_f32 v84, v84, v85
    v_cvt_pk_bf16_f32 v85, v86, v87
    s_nop 1
    ds_write_b64 v245, v[84:85] offset:8320
    v_mul_f32_e32 v88, v230, v88
    v_mul_f32_e32 v89, v230, v89
    v_mul_f32_e32 v90, v230, v90
    v_mul_f32_e32 v91, v230, v91
    v_cvt_pk_bf16_f32 v88, v88, v89
    v_cvt_pk_bf16_f32 v89, v90, v91
    ds_write_b64 v246, v[88:89] offset:8320
    v_mul_f32_e32 v92, v230, v92
    v_mul_f32_e32 v93, v230, v93
    v_mul_f32_e32 v94, v230, v94
    v_mul_f32_e32 v95, v230, v95
    v_cvt_pk_bf16_f32 v92, v92, v93
    v_cvt_pk_bf16_f32 v93, v94, v95
    ds_write_b64 v247, v[92:93] offset:8320
    ds_read_b128 a[192:195], v241 offset:8192
    ds_read_b128 a[196:199], v242 offset:9216
    ds_read_b128 a[200:203], v241 offset:10240
    ds_read_b128 a[204:207], v242 offset:11264
    v_accvgpr_read_b32 v227, a236
    v_rcp_f32_e32 v231, v227
    v_cmp_nge_f32_e64 s[88:89], v237, v227
    s_or_b64 vcc, vcc, s[88:89]
    v_pk_mul_f32 v[96:97], v[96:97], v[230:231] op_sel:[0,1]
    v_pk_mul_f32 v[98:99], v[98:99], v[230:231] op_sel:[0,1]
    v_cvt_pk_bf16_f32 v96, v96, v97
    v_cvt_pk_bf16_f32 v97, v98, v99
    v_pk_mul_f32 v[100:101], v[100:101], v[230:231] op_sel:[0,1]
    v_pk_mul_f32 v[102:103], v[102:103], v[230:231] op_sel:[0,1]
    v_cvt_pk_bf16_f32 v100, v100, v101
    v_cvt_pk_bf16_f32 v101, v102, v103
    v_pk_mul_f32 v[104:105], v[104:105], v[230:231] op_sel:[0,1]
    v_pk_mul_f32 v[106:107], v[106:107], v[230:231] op_sel:[0,1]
    v_cvt_pk_bf16_f32 v104, v104, v105
    v_cvt_pk_bf16_f32 v105, v106, v107
    v_pk_mul_f32 v[108:109], v[108:109], v[230:231] op_sel:[0,1]
    v_pk_mul_f32 v[110:111], v[110:111], v[230:231] op_sel:[0,1]
    v_cvt_pk_bf16_f32 v108, v108, v109
    v_cvt_pk_bf16_f32 v109, v110, v111
    v_pk_mul_f32 v[112:113], v[112:113], v[230:231] op_sel:[0,1]
    v_pk_mul_f32 v[114:115], v[114:115], v[230:231] op_sel:[0,1]
    v_cvt_pk_bf16_f32 v112, v112, v113
    v_cvt_pk_bf16_f32 v113, v114, v115
    v_pk_mul_f32 v[116:117], v[116:117], v[230:231] op_sel:[0,1]
    v_pk_mul_f32 v[118:119], v[118:119], v[230:231] op_sel:[0,1]
    v_cvt_pk_bf16_f32 v116, v116, v117
    v_cvt_pk_bf16_f32 v117, v118, v119
    v_pk_mul_f32 v[120:121], v[120:121], v[230:231] op_sel:[0,1]
    v_pk_mul_f32 v[122:123], v[122:123], v[230:231] op_sel:[0,1]
    v_cvt_pk_bf16_f32 v120, v120, v121
    v_cvt_pk_bf16_f32 v121, v122, v123
    v_pk_mul_f32 v[124:125], v[124:125], v[230:231] op_sel:[0,1]
    v_pk_mul_f32 v[126:127], v[126:127], v[230:231] op_sel:[0,1]
    v_cvt_pk_bf16_f32 v124, v124, v125
    v_cvt_pk_bf16_f32 v125, v126, v127
    ds_write_b64 v244, v[96:97] offset:12288
    ds_write_b64 v245, v[100:101] offset:12288
    ds_write_b64 v246, v[104:105] offset:12288
    ds_write_b64 v247, v[108:109] offset:12288
    ds_write_b64 v244, v[112:113] offset:12416
    ds_write_b64 v245, v[116:117] offset:12416
    ds_write_b64 v246, v[120:121] offset:12416
    ds_write_b64 v247, v[124:125] offset:12416
    ds_read_b128 a[208:211], v241 offset:12288
    ds_read_b128 a[212:215], v242 offset:13312
    ds_read_b128 a[216:219], v241 offset:14336
    ds_read_b128 a[220:223], v242 offset:15360
    s_waitcnt lgkmcnt(15)
    buffer_store_dwordx4 a[192:195], v243, s[24:27], s34 offen sc1
    s_waitcnt lgkmcnt(14)
    buffer_store_dwordx4 a[196:199], v243, s[24:27], s34 offen offset:1024 sc1
    s_waitcnt lgkmcnt(13)
    buffer_store_dwordx4 a[200:203], v243, s[24:27], s34 offen offset:2048 sc1
    s_waitcnt lgkmcnt(12)
    buffer_store_dwordx4 a[204:207], v243, s[24:27], s34 offen offset:3072 sc1
    s_waitcnt lgkmcnt(3)
    buffer_store_dwordx4 a[208:211], v243, s[24:27], s35 offen sc1
    s_waitcnt lgkmcnt(2)
    buffer_store_dwordx4 a[212:215], v243, s[24:27], s35 offen offset:1024 sc1
    s_waitcnt lgkmcnt(1)
    buffer_store_dwordx4 a[216:219], v243, s[24:27], s35 offen offset:2048 sc1
    s_waitcnt lgkmcnt(0)
    buffer_store_dwordx4 a[220:223], v243, s[24:27], s35 offen offset:3072 sc1
    s_cbranch_vccnz L_safe
L_end:
    s_endpgm
L_safe:
    s_nop 15
    s_waitcnt vmcnt(0) lgkmcnt(0)
    v_lshrrev_b32_e32 v232, 4, v223
    v_and_b32_e32 v233, 15, v223
    v_xor_b32_e32 v232, v232, v233
    v_lshlrev_b32_e32 v232, 4, v232
    v_lshl_add_u32 v232, v233, 8, v232
    v_add_u32_e32 v208, s31, v232
    v_xor_b32_e32 v209, 64, v208
    v_xor_b32_e32 v210, 128, v208
    v_xor_b32_e32 v211, 192, v208
    s_sub_u32 s38, s31, 40960
    v_add_u32_e32 v212, s38, v212
    v_add_u32_e32 v213, s38, v213
    v_add_u32_e32 v214, s38, v214
    v_add_u32_e32 v215, s38, v215
    v_add_u32_e32 v216, s38, v216
    v_add_u32_e32 v217, s38, v217
    v_add_u32_e32 v218, s38, v218
    v_add_u32_e32 v219, s38, v219
    s_and_b32 s38, s28, 1
    s_lshl_b32 s38, s38, 7
    s_or_b32 s38, s38, s30
    v_xor_b32_e32 v221, s38, v221
    v_mov_b32_e32 v0, 0
    v_mov_b32_e32 v1, 0
    v_mov_b32_e32 v2, 0
    v_mov_b32_e32 v3, 0
    v_mov_b32_e32 v4, 0
    v_mov_b32_e32 v5, 0
    v_mov_b32_e32 v6, 0
    v_mov_b32_e32 v7, 0
    v_mov_b32_e32 v8, 0
    v_mov_b32_e32 v9, 0
    v_mov_b32_e32 v10, 0
    v_mov_b32_e32 v11, 0
    v_mov_b32_e32 v12, 0
    v_mov_b32_e32 v13, 0
    v_mov_b32_e32 v14, 0
    v_mov_b32_e32 v15, 0
    v_mov_b32_e32 v16, 0
    v_mov_b32_e32 v17, 0
    v_mov_b32_e32 v18, 0
    v_mov_b32_e32 v19, 0
    v_mov_b32_e32 v20, 0
    v_mov_b32_e32 v21, 0
    v_mov_b32_e32 v22, 0
    v_mov_b32_e32 v23, 0
    v_mov_b32_e32 v24, 0
    v_mov_b32_e32 v25, 0
    v_mov_b32_e32 v26, 0
    v_mov_b32_e32 v27, 0
    v_mov_b32_e32 v28, 0
    v_mov_b32_e32 v29, 0
    v_mov_b32_e32 v30, 0
    v_mov_b32_e32 v31, 0
    v_mov_b32_e32 v32, 0
    v_mov_b32_e32 v33, 0
    v_mov_b32_e32 v34, 0
    v_mov_b32_e32 v35, 0
    v_mov_b32_e32 v36, 0
    v_mov_b32_e32 v37, 0
    v_mov_b32_e32 v38, 0
    v_mov_b32_e32 v39, 0
    v_mov_b32_e32 v40, 0
    v_mov_b32_e32 v41, 0
    v_mov_b32_e32 v42, 0
    v_mov_b32_e32 v43, 0
    v_mov_b32_e32 v44, 0
    v_mov_b32_e32 v45, 0
    v_mov_b32_e32 v46, 0
    v_mov_b32_e32 v47, 0
    v_mov_b32_e32 v48, 0
    v_mov_b32_e32 v49, 0
    v_mov_b32_e32 v50, 0
    v_mov_b32_e32 v51, 0
    v_mov_b32_e32 v52, 0
    v_mov_b32_e32 v53, 0
    v_mov_b32_e32 v54, 0
    v_mov_b32_e32 v55, 0
    v_mov_b32_e32 v56, 0
    v_mov_b32_e32 v57, 0
    v_mov_b32_e32 v58, 0
    v_mov_b32_e32 v59, 0
    v_mov_b32_e32 v60, 0
    v_mov_b32_e32 v61, 0
    v_mov_b32_e32 v62, 0
    v_mov_b32_e32 v63, 0
    v_mov_b32_e32 v64, 0
    v_mov_b32_e32 v65, 0
    v_mov_b32_e32 v66, 0
    v_mov_b32_e32 v67, 0
    v_mov_b32_e32 v68, 0
    v_mov_b32_e32 v69, 0
    v_mov_b32_e32 v70, 0
    v_mov_b32_e32 v71, 0
    v_mov_b32_e32 v72, 0
    v_mov_b32_e32 v73, 0
    v_mov_b32_e32 v74, 0
    v_mov_b32_e32 v75, 0
    v_mov_b32_e32 v76, 0
    v_mov_b32_e32 v77, 0
    v_mov_b32_e32 v78, 0
    v_mov_b32_e32 v79, 0
    v_mov_b32_e32 v80, 0
    v_mov_b32_e32 v81, 0
    v_mov_b32_e32 v82, 0
    v_mov_b32_e32 v83, 0
    v_mov_b32_e32 v84, 0
    v_mov_b32_e32 v85, 0
    v_mov_b32_e32 v86, 0
    v_mov_b32_e32 v87, 0
    v_mov_b32_e32 v88, 0
    v_mov_b32_e32 v89, 0
    v_mov_b32_e32 v90, 0
    v_mov_b32_e32 v91, 0
    v_mov_b32_e32 v92, 0
    v_mov_b32_e32 v93, 0
    v_mov_b32_e32 v94, 0
    v_mov_b32_e32 v95, 0
    v_mov_b32_e32 v96, 0
    v_mov_b32_e32 v97, 0
    v_mov_b32_e32 v98, 0
    v_mov_b32_e32 v99, 0
    v_mov_b32_e32 v100, 0
    v_mov_b32_e32 v101, 0
    v_mov_b32_e32 v102, 0
    v_mov_b32_e32 v103, 0
    v_mov_b32_e32 v104, 0
    v_mov_b32_e32 v105, 0
    v_mov_b32_e32 v106, 0
    v_mov_b32_e32 v107, 0
    v_mov_b32_e32 v108, 0
    v_mov_b32_e32 v109, 0
    v_mov_b32_e32 v110, 0
    v_mov_b32_e32 v111, 0
    v_mov_b32_e32 v112, 0
    v_mov_b32_e32 v113, 0
    v_mov_b32_e32 v114, 0
    v_mov_b32_e32 v115, 0
    v_mov_b32_e32 v116, 0
    v_mov_b32_e32 v117, 0
    v_mov_b32_e32 v118, 0
    v_mov_b32_e32 v119, 0
    v_mov_b32_e32 v120, 0
    v_mov_b32_e32 v121, 0
    v_mov_b32_e32 v122, 0
    v_mov_b32_e32 v123, 0
    v_mov_b32_e32 v124, 0
    v_mov_b32_e32 v125, 0
    v_mov_b32_e32 v126, 0
    v_mov_b32_e32 v127, 0
    v_mov_b32_e32 v224, 0
    v_mov_b32_e32 v228, 0xff800000
    v_mov_b32_e32 v225, 0
    v_mov_b32_e32 v229, 0xff800000
    v_mov_b32_e32 v226, 0
    v_mov_b32_e32 v230, 0xff800000
    v_mov_b32_e32 v227, 0
    v_mov_b32_e32 v231, 0xff800000
    s_mov_b32 s36, 0
L_safe_loop:
    v_xor_b32_e32 v232, 0, v222
    s_add_u32 m0, s31, 0
    s_nop 0
    buffer_load_dwordx4 v232, s[12:15], s36 offen lds
    v_xor_b32_e32 v233, 1088, v222
    s_add_u32 m0, s31, 1024
    s_nop 0
    buffer_load_dwordx4 v233, s[12:15], s36 offen lds
    v_xor_b32_e32 v232, 2176, v222
    s_add_u32 m0, s31, 2048
    s_nop 0
    buffer_load_dwordx4 v232, s[12:15], s36 offen lds
    v_xor_b32_e32 v233, 3264, v222
    s_add_u32 m0, s31, 3072
    s_nop 0
    buffer_load_dwordx4 v233, s[12:15], s36 offen lds
    v_xor_b32_e32 v232, 4096, v222
    s_add_u32 m0, s31, 4096
    s_nop 0
    buffer_load_dwordx4 v232, s[12:15], s36 offen lds
    v_xor_b32_e32 v233, 5184, v222
    s_add_u32 m0, s31, 5120
    s_nop 0
    buffer_load_dwordx4 v233, s[12:15], s36 offen lds
    v_xor_b32_e32 v232, 6272, v222
    s_add_u32 m0, s31, 6144
    s_nop 0
    buffer_load_dwordx4 v232, s[12:15], s36 offen lds
    v_xor_b32_e32 v233, 7360, v222
    s_add_u32 m0, s31, 7168
    s_nop 0
    buffer_load_dwordx4 v233, s[12:15], s36 offen lds
    v_xor_b32_e32 v232, 0, v221
    s_add_u32 m0, s31, 8192
    s_nop 0
    buffer_load_dwordx4 v232, s[20:23], s36 offen lds
    v_xor_b32_e32 v233, 1152, v221
    s_add_u32 m0, s31, 9216
    s_nop 0
    buffer_load_dwordx4 v233, s[20:23], s36 offen lds
    v_xor_b32_e32 v232, 2048, v221
    s_add_u32 m0, s31, 10240
    s_nop 0
    buffer_load_dwordx4 v232, s[20:23], s36 offen lds
    v_xor_b32_e32 v233, 3200, v221
    s_add_u32 m0, s31, 11264
    s_nop 0
    buffer_load_dwordx4 v233, s[20:23], s36 offen lds
    v_xor_b32_e32 v232, 4096, v221
    s_add_u32 m0, s31, 12288
    s_nop 0
    buffer_load_dwordx4 v232, s[20:23], s36 offen lds
    v_xor_b32_e32 v233, 5248, v221
    s_add_u32 m0, s31, 13312
    s_nop 0
    buffer_load_dwordx4 v233, s[20:23], s36 offen lds
    v_xor_b32_e32 v232, 6144, v221
    s_add_u32 m0, s31, 14336
    s_nop 0
    buffer_load_dwordx4 v232, s[20:23], s36 offen lds
    v_xor_b32_e32 v233, 7296, v221
    s_add_u32 m0, s31, 15360
    s_nop 0
    buffer_load_dwordx4 v233, s[20:23], s36 offen lds
    s_waitcnt vmcnt(0)
    ds_read_b128 a[64:67], v208
    ds_read_b128 a[68:71], v209
    ds_read_b128 a[72:75], v210
    ds_read_b128 a[76:79], v211
    ds_read_b128 a[80:83], v208 offset:4096
    ds_read_b128 a[84:87], v209 offset:4096
    ds_read_b128 a[88:91], v210 offset:4096
    ds_read_b128 a[92:95], v211 offset:4096
    s_waitcnt lgkmcnt(0)
    ds_read_b64_tr_b16 a[96:97], v212
    ds_read_b64_tr_b16 a[98:99], v212 offset:4096
    ds_read_b64_tr_b16 a[100:101], v213
    ds_read_b64_tr_b16 a[102:103], v213 offset:4096
    ds_read_b64_tr_b16 a[104:105], v214
    ds_read_b64_tr_b16 a[106:107], v214 offset:4096
    ds_read_b64_tr_b16 a[108:109], v215
    ds_read_b64_tr_b16 a[110:111], v215 offset:4096
    ds_read_b64_tr_b16 a[112:113], v216
    ds_read_b64_tr_b16 a[114:115], v216 offset:4096
    ds_read_b64_tr_b16 a[116:117], v217
    ds_read_b64_tr_b16 a[118:119], v217 offset:4096
    ds_read_b64_tr_b16 a[120:121], v218
    ds_read_b64_tr_b16 a[122:123], v218 offset:4096
    ds_read_b64_tr_b16 a[124:125], v219
    ds_read_b64_tr_b16 a[126:127], v219 offset:4096
    v_mfma_f32_16x16x32_bf16 v[128:131], a[64:67], a[0:3], 0
    v_mfma_f32_16x16x32_bf16 v[128:131], a[68:71], a[4:7], v[128:131]
    v_mfma_f32_16x16x32_bf16 v[128:131], a[72:75], a[8:11], v[128:131]
    v_mfma_f32_16x16x32_bf16 v[128:131], a[76:79], a[12:15], v[128:131]
    v_mfma_f32_16x16x32_bf16 v[132:135], a[80:83], a[0:3], 0
    v_mfma_f32_16x16x32_bf16 v[132:135], a[84:87], a[4:7], v[132:135]
    v_mfma_f32_16x16x32_bf16 v[132:135], a[88:91], a[8:11], v[132:135]
    v_mfma_f32_16x16x32_bf16 v[132:135], a[92:95], a[12:15], v[132:135]
    v_mfma_f32_16x16x32_bf16 v[136:139], a[64:67], a[16:19], 0
    v_mfma_f32_16x16x32_bf16 v[136:139], a[68:71], a[20:23], v[136:139]
    v_mfma_f32_16x16x32_bf16 v[136:139], a[72:75], a[24:27], v[136:139]
    v_mfma_f32_16x16x32_bf16 v[136:139], a[76:79], a[28:31], v[136:139]
    v_mfma_f32_16x16x32_bf16 v[140:143], a[80:83], a[16:19], 0
    v_mfma_f32_16x16x32_bf16 v[140:143], a[84:87], a[20:23], v[140:143]
    v_mfma_f32_16x16x32_bf16 v[140:143], a[88:91], a[24:27], v[140:143]
    v_mfma_f32_16x16x32_bf16 v[140:143], a[92:95], a[28:31], v[140:143]
    v_mfma_f32_16x16x32_bf16 v[144:147], a[64:67], a[32:35], 0
    v_mfma_f32_16x16x32_bf16 v[144:147], a[68:71], a[36:39], v[144:147]
    v_mfma_f32_16x16x32_bf16 v[144:147], a[72:75], a[40:43], v[144:147]
    v_mfma_f32_16x16x32_bf16 v[144:147], a[76:79], a[44:47], v[144:147]
    v_mfma_f32_16x16x32_bf16 v[148:151], a[80:83], a[32:35], 0
    v_mfma_f32_16x16x32_bf16 v[148:151], a[84:87], a[36:39], v[148:151]
    v_mfma_f32_16x16x32_bf16 v[148:151], a[88:91], a[40:43], v[148:151]
    v_mfma_f32_16x16x32_bf16 v[148:151], a[92:95], a[44:47], v[148:151]
    v_mfma_f32_16x16x32_bf16 v[152:155], a[64:67], a[48:51], 0
    v_mfma_f32_16x16x32_bf16 v[152:155], a[68:71], a[52:55], v[152:155]
    v_mfma_f32_16x16x32_bf16 v[152:155], a[72:75], a[56:59], v[152:155]
    v_mfma_f32_16x16x32_bf16 v[152:155], a[76:79], a[60:63], v[152:155]
    v_mfma_f32_16x16x32_bf16 v[156:159], a[80:83], a[48:51], 0
    v_mfma_f32_16x16x32_bf16 v[156:159], a[84:87], a[52:55], v[156:159]
    v_mfma_f32_16x16x32_bf16 v[156:159], a[88:91], a[56:59], v[156:159]
    v_mfma_f32_16x16x32_bf16 v[156:159], a[92:95], a[60:63], v[156:159]
    s_nop 7
    v_max3_f32 v232, v128, v129, v130
    v_max3_f32 v233, v131, v132, v133
    v_max3_f32 v232, v232, v134, v135
    v_max3_f32 v232, v232, v233, v228
    v_mov_b32_e32 v233, v232
    s_nop 1
    v_permlane16_swap_b32 v232, v233
    v_max_f32_e32 v232, v232, v233
    v_mov_b32_e32 v233, v232
    s_nop 1
    v_permlane32_swap_b32 v232, v233
    v_max_f32_e32 v232, v232, v233
    v_sub_f32_e32 v236, v228, v232
    v_exp_f32_e32 v236, v236
    v_mov_b32_e32 v228, v232
    v_sub_f32_e32 v192, 0, v232
    v_mul_f32_e32 v224, v236, v224
    v_mul_f32_e32 v0, v236, v0
    v_mul_f32_e32 v1, v236, v1
    v_mul_f32_e32 v2, v236, v2
    v_mul_f32_e32 v3, v236, v3
    v_mul_f32_e32 v4, v236, v4
    v_mul_f32_e32 v5, v236, v5
    v_mul_f32_e32 v6, v236, v6
    v_mul_f32_e32 v7, v236, v7
    v_mul_f32_e32 v8, v236, v8
    v_mul_f32_e32 v9, v236, v9
    v_mul_f32_e32 v10, v236, v10
    v_mul_f32_e32 v11, v236, v11
    v_mul_f32_e32 v12, v236, v12
    v_mul_f32_e32 v13, v236, v13
    v_mul_f32_e32 v14, v236, v14
    v_mul_f32_e32 v15, v236, v15
    v_mul_f32_e32 v16, v236, v16
    v_mul_f32_e32 v17, v236, v17
    v_mul_f32_e32 v18, v236, v18
    v_mul_f32_e32 v19, v236, v19
    v_mul_f32_e32 v20, v236, v20
    v_mul_f32_e32 v21, v236, v21
    v_mul_f32_e32 v22, v236, v22
    v_mul_f32_e32 v23, v236, v23
    v_mul_f32_e32 v24, v236, v24
    v_mul_f32_e32 v25, v236, v25
    v_mul_f32_e32 v26, v236, v26
    v_mul_f32_e32 v27, v236, v27
    v_mul_f32_e32 v28, v236, v28
    v_mul_f32_e32 v29, v236, v29
    v_mul_f32_e32 v30, v236, v30
    v_mul_f32_e32 v31, v236, v31
    v_add_f32_e32 v128, v192, v128
    v_add_f32_e32 v129, v192, v129
    v_add_f32_e32 v130, v192, v130
    v_add_f32_e32 v131, v192, v131
    v_exp_f32_e32 v128, v128
    v_exp_f32_e32 v129, v129
    v_exp_f32_e32 v130, v130
    v_exp_f32_e32 v131, v131
    s_nop 0
    v_add_f32_e32 v224, v224, v128
    v_add_f32_e32 v224, v224, v129
    v_add_f32_e32 v224, v224, v130
    v_add_f32_e32 v224, v224, v131
    v_cvt_pk_bf16_f32 v160, v128, v129
    v_cvt_pk_bf16_f32 v161, v130, v131
    v_add_f32_e32 v132, v192, v132
    v_add_f32_e32 v133, v192, v133
    v_add_f32_e32 v134, v192, v134
    v_add_f32_e32 v135, v192, v135
    v_exp_f32_e32 v132, v132
    v_exp_f32_e32 v133, v133
    v_exp_f32_e32 v134, v134
    v_exp_f32_e32 v135, v135
    s_nop 0
    v_add_f32_e32 v224, v224, v132
    v_add_f32_e32 v224, v224, v133
    v_add_f32_e32 v224, v224, v134
    v_add_f32_e32 v224, v224, v135
    v_cvt_pk_bf16_f32 v162, v132, v133
    v_cvt_pk_bf16_f32 v163, v134, v135
    v_max3_f32 v232, v136, v137, v138
    v_max3_f32 v233, v139, v140, v141
    v_max3_f32 v232, v232, v142, v143
    v_max3_f32 v232, v232, v233, v229
    v_mov_b32_e32 v233, v232
    s_nop 1
    v_permlane16_swap_b32 v232, v233
    v_max_f32_e32 v232, v232, v233
    v_mov_b32_e32 v233, v232
    s_nop 1
    v_permlane32_swap_b32 v232, v233
    v_max_f32_e32 v232, v232, v233
    v_sub_f32_e32 v236, v229, v232
    v_exp_f32_e32 v236, v236
    v_mov_b32_e32 v229, v232
    v_sub_f32_e32 v196, 0, v232
    v_mul_f32_e32 v225, v236, v225
    v_mul_f32_e32 v32, v236, v32
    v_mul_f32_e32 v33, v236, v33
    v_mul_f32_e32 v34, v236, v34
    v_mul_f32_e32 v35, v236, v35
    v_mul_f32_e32 v36, v236, v36
    v_mul_f32_e32 v37, v236, v37
    v_mul_f32_e32 v38, v236, v38
    v_mul_f32_e32 v39, v236, v39
    v_mul_f32_e32 v40, v236, v40
    v_mul_f32_e32 v41, v236, v41
    v_mul_f32_e32 v42, v236, v42
    v_mul_f32_e32 v43, v236, v43
    v_mul_f32_e32 v44, v236, v44
    v_mul_f32_e32 v45, v236, v45
    v_mul_f32_e32 v46, v236, v46
    v_mul_f32_e32 v47, v236, v47
    v_mul_f32_e32 v48, v236, v48
    v_mul_f32_e32 v49, v236, v49
    v_mul_f32_e32 v50, v236, v50
    v_mul_f32_e32 v51, v236, v51
    v_mul_f32_e32 v52, v236, v52
    v_mul_f32_e32 v53, v236, v53
    v_mul_f32_e32 v54, v236, v54
    v_mul_f32_e32 v55, v236, v55
    v_mul_f32_e32 v56, v236, v56
    v_mul_f32_e32 v57, v236, v57
    v_mul_f32_e32 v58, v236, v58
    v_mul_f32_e32 v59, v236, v59
    v_mul_f32_e32 v60, v236, v60
    v_mul_f32_e32 v61, v236, v61
    v_mul_f32_e32 v62, v236, v62
    v_mul_f32_e32 v63, v236, v63
    v_add_f32_e32 v136, v196, v136
    v_add_f32_e32 v137, v196, v137
    v_add_f32_e32 v138, v196, v138
    v_add_f32_e32 v139, v196, v139
    v_exp_f32_e32 v136, v136
    v_exp_f32_e32 v137, v137
    v_exp_f32_e32 v138, v138
    v_exp_f32_e32 v139, v139
    s_nop 0
    v_add_f32_e32 v225, v225, v136
    v_add_f32_e32 v225, v225, v137
    v_add_f32_e32 v225, v225, v138
    v_add_f32_e32 v225, v225, v139
    v_cvt_pk_bf16_f32 v164, v136, v137
    v_cvt_pk_bf16_f32 v165, v138, v139
    v_add_f32_e32 v140, v196, v140
    v_add_f32_e32 v141, v196, v141
    v_add_f32_e32 v142, v196, v142
    v_add_f32_e32 v143, v196, v143
    v_exp_f32_e32 v140, v140
    v_exp_f32_e32 v141, v141
    v_exp_f32_e32 v142, v142
    v_exp_f32_e32 v143, v143
    s_nop 0
    v_add_f32_e32 v225, v225, v140
    v_add_f32_e32 v225, v225, v141
    v_add_f32_e32 v225, v225, v142
    v_add_f32_e32 v225, v225, v143
    v_cvt_pk_bf16_f32 v166, v140, v141
    v_cvt_pk_bf16_f32 v167, v142, v143
    v_max3_f32 v232, v144, v145, v146
    v_max3_f32 v233, v147, v148, v149
    v_max3_f32 v232, v232, v150, v151
    v_max3_f32 v232, v232, v233, v230
    v_mov_b32_e32 v233, v232
    s_nop 1
    v_permlane16_swap_b32 v232, v233
    v_max_f32_e32 v232, v232, v233
    v_mov_b32_e32 v233, v232
    s_nop 1
    v_permlane32_swap_b32 v232, v233
    v_max_f32_e32 v232, v232, v233
    v_sub_f32_e32 v236, v230, v232
    v_exp_f32_e32 v236, v236
    v_mov_b32_e32 v230, v232
    v_sub_f32_e32 v200, 0, v232
    v_mul_f32_e32 v226, v236, v226
    v_mul_f32_e32 v64, v236, v64
    v_mul_f32_e32 v65, v236, v65
    v_mul_f32_e32 v66, v236, v66
    v_mul_f32_e32 v67, v236, v67
    v_mul_f32_e32 v68, v236, v68
    v_mul_f32_e32 v69, v236, v69
    v_mul_f32_e32 v70, v236, v70
    v_mul_f32_e32 v71, v236, v71
    v_mul_f32_e32 v72, v236, v72
    v_mul_f32_e32 v73, v236, v73
    v_mul_f32_e32 v74, v236, v74
    v_mul_f32_e32 v75, v236, v75
    v_mul_f32_e32 v76, v236, v76
    v_mul_f32_e32 v77, v236, v77
    v_mul_f32_e32 v78, v236, v78
    v_mul_f32_e32 v79, v236, v79
    v_mul_f32_e32 v80, v236, v80
    v_mul_f32_e32 v81, v236, v81
    v_mul_f32_e32 v82, v236, v82
    v_mul_f32_e32 v83, v236, v83
    v_mul_f32_e32 v84, v236, v84
    v_mul_f32_e32 v85, v236, v85
    v_mul_f32_e32 v86, v236, v86
    v_mul_f32_e32 v87, v236, v87
    v_mul_f32_e32 v88, v236, v88
    v_mul_f32_e32 v89, v236, v89
    v_mul_f32_e32 v90, v236, v90
    v_mul_f32_e32 v91, v236, v91
    v_mul_f32_e32 v92, v236, v92
    v_mul_f32_e32 v93, v236, v93
    v_mul_f32_e32 v94, v236, v94
    v_mul_f32_e32 v95, v236, v95
    v_add_f32_e32 v144, v200, v144
    v_add_f32_e32 v145, v200, v145
    v_add_f32_e32 v146, v200, v146
    v_add_f32_e32 v147, v200, v147
    v_exp_f32_e32 v144, v144
    v_exp_f32_e32 v145, v145
    v_exp_f32_e32 v146, v146
    v_exp_f32_e32 v147, v147
    s_nop 0
    v_add_f32_e32 v226, v226, v144
    v_add_f32_e32 v226, v226, v145
    v_add_f32_e32 v226, v226, v146
    v_add_f32_e32 v226, v226, v147
    v_cvt_pk_bf16_f32 v168, v144, v145
    v_cvt_pk_bf16_f32 v169, v146, v147
    v_add_f32_e32 v148, v200, v148
    v_add_f32_e32 v149, v200, v149
    v_add_f32_e32 v150, v200, v150
    v_add_f32_e32 v151, v200, v151
    v_exp_f32_e32 v148, v148
    v_exp_f32_e32 v149, v149
    v_exp_f32_e32 v150, v150
    v_exp_f32_e32 v151, v151
    s_nop 0
    v_add_f32_e32 v226, v226, v148
    v_add_f32_e32 v226, v226, v149
    v_add_f32_e32 v226, v226, v150
    v_add_f32_e32 v226, v226, v151
    v_cvt_pk_bf16_f32 v170, v148, v149
    v_cvt_pk_bf16_f32 v171, v150, v151
    v_max3_f32 v232, v152, v153, v154
    v_max3_f32 v233, v155, v156, v157
    v_max3_f32 v232, v232, v158, v159
    v_max3_f32 v232, v232, v233, v231
    v_mov_b32_e32 v233, v232
    s_nop 1
    v_permlane16_swap_b32 v232, v233
    v_max_f32_e32 v232, v232, v233
    v_mov_b32_e32 v233, v232
    s_nop 1
    v_permlane32_swap_b32 v232, v233
    v_max_f32_e32 v232, v232, v233
    v_sub_f32_e32 v236, v231, v232
    v_exp_f32_e32 v236, v236
    v_mov_b32_e32 v231, v232
    v_sub_f32_e32 v204, 0, v232
    v_mul_f32_e32 v227, v236, v227
    v_mul_f32_e32 v96, v236, v96
    v_mul_f32_e32 v97, v236, v97
    v_mul_f32_e32 v98, v236, v98
    v_mul_f32_e32 v99, v236, v99
    v_mul_f32_e32 v100, v236, v100
    v_mul_f32_e32 v101, v236, v101
    v_mul_f32_e32 v102, v236, v102
    v_mul_f32_e32 v103, v236, v103
    v_mul_f32_e32 v104, v236, v104
    v_mul_f32_e32 v105, v236, v105
    v_mul_f32_e32 v106, v236, v106
    v_mul_f32_e32 v107, v236, v107
    v_mul_f32_e32 v108, v236, v108
    v_mul_f32_e32 v109, v236, v109
    v_mul_f32_e32 v110, v236, v110
    v_mul_f32_e32 v111, v236, v111
    v_mul_f32_e32 v112, v236, v112
    v_mul_f32_e32 v113, v236, v113
    v_mul_f32_e32 v114, v236, v114
    v_mul_f32_e32 v115, v236, v115
    v_mul_f32_e32 v116, v236, v116
    v_mul_f32_e32 v117, v236, v117
    v_mul_f32_e32 v118, v236, v118
    v_mul_f32_e32 v119, v236, v119
    v_mul_f32_e32 v120, v236, v120
    v_mul_f32_e32 v121, v236, v121
    v_mul_f32_e32 v122, v236, v122
    v_mul_f32_e32 v123, v236, v123
    v_mul_f32_e32 v124, v236, v124
    v_mul_f32_e32 v125, v236, v125
    v_mul_f32_e32 v126, v236, v126
    v_mul_f32_e32 v127, v236, v127
    v_add_f32_e32 v152, v204, v152
    v_add_f32_e32 v153, v204, v153
    v_add_f32_e32 v154, v204, v154
    v_add_f32_e32 v155, v204, v155
    v_exp_f32_e32 v152, v152
    v_exp_f32_e32 v153, v153
    v_exp_f32_e32 v154, v154
    v_exp_f32_e32 v155, v155
    s_nop 0
    v_add_f32_e32 v227, v227, v152
    v_add_f32_e32 v227, v227, v153
    v_add_f32_e32 v227, v227, v154
    v_add_f32_e32 v227, v227, v155
    v_cvt_pk_bf16_f32 v172, v152, v153
    v_cvt_pk_bf16_f32 v173, v154, v155
    v_add_f32_e32 v156, v204, v156
    v_add_f32_e32 v157, v204, v157
    v_add_f32_e32 v158, v204, v158
    v_add_f32_e32 v159, v204, v159
    v_exp_f32_e32 v156, v156
    v_exp_f32_e32 v157, v157
    v_exp_f32_e32 v158, v158
    v_exp_f32_e32 v159, v159
    s_nop 0
    v_add_f32_e32 v227, v227, v156
    v_add_f32_e32 v227, v227, v157
    v_add_f32_e32 v227, v227, v158
    v_add_f32_e32 v227, v227, v159
    v_cvt_pk_bf16_f32 v174, v156, v157
    v_cvt_pk_bf16_f32 v175, v158, v159
    s_waitcnt lgkmcnt(0)
    s_nop 1
    v_mfma_f32_16x16x32_bf16 v[0:3], a[96:99], v[160:163], v[0:3]
    v_mfma_f32_16x16x32_bf16 v[4:7], a[100:103], v[160:163], v[4:7]
    v_mfma_f32_16x16x32_bf16 v[8:11], a[104:107], v[160:163], v[8:11]
    v_mfma_f32_16x16x32_bf16 v[12:15], a[108:111], v[160:163], v[12:15]
    v_mfma_f32_16x16x32_bf16 v[16:19], a[112:115], v[160:163], v[16:19]
    v_mfma_f32_16x16x32_bf16 v[20:23], a[116:119], v[160:163], v[20:23]
    v_mfma_f32_16x16x32_bf16 v[24:27], a[120:123], v[160:163], v[24:27]
    v_mfma_f32_16x16x32_bf16 v[28:31], a[124:127], v[160:163], v[28:31]
    v_mfma_f32_16x16x32_bf16 v[32:35], a[96:99], v[164:167], v[32:35]
    v_mfma_f32_16x16x32_bf16 v[36:39], a[100:103], v[164:167], v[36:39]
    v_mfma_f32_16x16x32_bf16 v[40:43], a[104:107], v[164:167], v[40:43]
    v_mfma_f32_16x16x32_bf16 v[44:47], a[108:111], v[164:167], v[44:47]
    v_mfma_f32_16x16x32_bf16 v[48:51], a[112:115], v[164:167], v[48:51]
    v_mfma_f32_16x16x32_bf16 v[52:55], a[116:119], v[164:167], v[52:55]
    v_mfma_f32_16x16x32_bf16 v[56:59], a[120:123], v[164:167], v[56:59]
    v_mfma_f32_16x16x32_bf16 v[60:63], a[124:127], v[164:167], v[60:63]
    v_mfma_f32_16x16x32_bf16 v[64:67], a[96:99], v[168:171], v[64:67]
    v_mfma_f32_16x16x32_bf16 v[68:71], a[100:103], v[168:171], v[68:71]
    v_mfma_f32_16x16x32_bf16 v[72:75], a[104:107], v[168:171], v[72:75]
    v_mfma_f32_16x16x32_bf16 v[76:79], a[108:111], v[168:171], v[76:79]
    v_mfma_f32_16x16x32_bf16 v[80:83], a[112:115], v[168:171], v[80:83]
    v_mfma_f32_16x16x32_bf16 v[84:87], a[116:119], v[168:171], v[84:87]
    v_mfma_f32_16x16x32_bf16 v[88:91], a[120:123], v[168:171], v[88:91]
    v_mfma_f32_16x16x32_bf16 v[92:95], a[124:127], v[168:171], v[92:95]
    v_mfma_f32_16x16x32_bf16 v[96:99], a[96:99], v[172:175], v[96:99]
    v_mfma_f32_16x16x32_bf16 v[100:103], a[100:103], v[172:175], v[100:103]
    v_mfma_f32_16x16x32_bf16 v[104:107], a[104:107], v[172:175], v[104:107]
    v_mfma_f32_16x16x32_bf16 v[108:111], a[108:111], v[172:175], v[108:111]
    v_mfma_f32_16x16x32_bf16 v[112:115], a[112:115], v[172:175], v[112:115]
    v_mfma_f32_16x16x32_bf16 v[116:119], a[116:119], v[172:175], v[116:119]
    v_mfma_f32_16x16x32_bf16 v[120:123], a[120:123], v[172:175], v[120:123]
    v_mfma_f32_16x16x32_bf16 v[124:127], a[124:127], v[172:175], v[124:127]
    s_add_u32 s36, s36, 8192
    s_cmp_lt_u32 s36, 131072
    s_nop 7
    s_cbranch_scc1 L_safe_loop
    v_lshrrev_b32_e32 v232, 5, v223
    v_and_b32_e32 v233, 7, v223
    v_xor_b32_e32 v232, v232, v233
    v_lshlrev_b32_e32 v232, 4, v232
    v_bfe_u32 v233, v223, 4, 1
    v_lshl_add_u32 v232, v233, 3, v232
    v_and_b32_e32 v233, 15, v223
    v_lshl_add_u32 v232, v233, 8, v232
    v_add_u32_e32 v244, s31, v232
    v_xor_b32_e32 v245, 32, v244
    v_xor_b32_e32 v246, 64, v244
    v_xor_b32_e32 v247, 96, v244
    v_mov_b32_e32 v232, v224
    s_nop 1
    v_permlane16_swap_b32 v224, v232
    v_add_f32_e32 v224, v224, v232
    v_mov_b32_e32 v232, v224
    s_nop 1
    v_permlane32_swap_b32 v224, v232
    v_add_f32_e32 v224, v224, v232
    v_rcp_f32_e32 v228, v224
    v_mov_b32_e32 v234, v225
    s_nop 1
    v_permlane16_swap_b32 v225, v234
    v_add_f32_e32 v225, v225, v234
    v_mov_b32_e32 v234, v225
    s_nop 1
    v_permlane32_swap_b32 v225, v234
    v_add_f32_e32 v225, v225, v234
    v_rcp_f32_e32 v229, v225
    v_mov_b32_e32 v232, v226
    s_nop 1
    v_permlane16_swap_b32 v226, v232
    v_add_f32_e32 v226, v226, v232
    v_mov_b32_e32 v232, v226
    s_nop 1
    v_permlane32_swap_b32 v226, v232
    v_add_f32_e32 v226, v226, v232
    v_rcp_f32_e32 v230, v226
    v_mov_b32_e32 v234, v227
    s_nop 1
    v_permlane16_swap_b32 v227, v234
    v_add_f32_e32 v227, v227, v234
    v_mov_b32_e32 v234, v227
    s_nop 1
    v_permlane32_swap_b32 v227, v234
    v_add_f32_e32 v227, v227, v234
    v_rcp_f32_e32 v231, v227
    s_nop 0
    v_mul_f32_e32 v0, v228, v0
    v_mul_f32_e32 v1, v228, v1
    v_mul_f32_e32 v2, v228, v2
    v_mul_f32_e32 v3, v228, v3
    v_cvt_pk_bf16_f32 v0, v0, v1
    v_cvt_pk_bf16_f32 v1, v2, v3
    ds_write_b64 v244, v[0:1]
    v_mul_f32_e32 v4, v228, v4
    v_mul_f32_e32 v5, v228, v5
    v_mul_f32_e32 v6, v228, v6
    v_mul_f32_e32 v7, v228, v7
    v_cvt_pk_bf16_f32 v4, v4, v5
    v_cvt_pk_bf16_f32 v5, v6, v7
    ds_write_b64 v245, v[4:5]
    v_mul_f32_e32 v8, v228, v8
    v_mul_f32_e32 v9, v228, v9
    v_mul_f32_e32 v10, v228, v10
    v_mul_f32_e32 v11, v228, v11
    v_cvt_pk_bf16_f32 v8, v8, v9
    v_cvt_pk_bf16_f32 v9, v10, v11
    ds_write_b64 v246, v[8:9]
    v_mul_f32_e32 v12, v228, v12
    v_mul_f32_e32 v13, v228, v13
    v_mul_f32_e32 v14, v228, v14
    v_mul_f32_e32 v15, v228, v15
    v_cvt_pk_bf16_f32 v12, v12, v13
    v_cvt_pk_bf16_f32 v13, v14, v15
    ds_write_b64 v247, v[12:13]
    v_mul_f32_e32 v16, v228, v16
    v_mul_f32_e32 v17, v228, v17
    v_mul_f32_e32 v18, v228, v18
    v_mul_f32_e32 v19, v228, v19
    v_cvt_pk_bf16_f32 v16, v16, v17
    v_cvt_pk_bf16_f32 v17, v18, v19
    ds_write_b64 v244, v[16:17] offset:128
    v_mul_f32_e32 v20, v228, v20
    v_mul_f32_e32 v21, v228, v21
    v_mul_f32_e32 v22, v228, v22
    v_mul_f32_e32 v23, v228, v23
    v_cvt_pk_bf16_f32 v20, v20, v21
    v_cvt_pk_bf16_f32 v21, v22, v23
    ds_write_b64 v245, v[20:21] offset:128
    v_mul_f32_e32 v24, v228, v24
    v_mul_f32_e32 v25, v228, v25
    v_mul_f32_e32 v26, v228, v26
    v_mul_f32_e32 v27, v228, v27
    v_cvt_pk_bf16_f32 v24, v24, v25
    v_cvt_pk_bf16_f32 v25, v26, v27
    ds_write_b64 v246, v[24:25] offset:128
    v_mul_f32_e32 v28, v228, v28
    v_mul_f32_e32 v29, v228, v29
    v_mul_f32_e32 v30, v228, v30
    v_mul_f32_e32 v31, v228, v31
    v_cvt_pk_bf16_f32 v28, v28, v29
    v_cvt_pk_bf16_f32 v29, v30, v31
    ds_write_b64 v247, v[28:29] offset:128
    v_mul_f32_e32 v32, v229, v32
    v_mul_f32_e32 v33, v229, v33
    v_mul_f32_e32 v34, v229, v34
    v_mul_f32_e32 v35, v229, v35
    v_cvt_pk_bf16_f32 v32, v32, v33
    v_cvt_pk_bf16_f32 v33, v34, v35
    ds_write_b64 v244, v[32:33] offset:4096
    v_mul_f32_e32 v36, v229, v36
    v_mul_f32_e32 v37, v229, v37
    v_mul_f32_e32 v38, v229, v38
    v_mul_f32_e32 v39, v229, v39
    v_cvt_pk_bf16_f32 v36, v36, v37
    v_cvt_pk_bf16_f32 v37, v38, v39
    ds_write_b64 v245, v[36:37] offset:4096
    v_mul_f32_e32 v40, v229, v40
    v_mul_f32_e32 v41, v229, v41
    v_mul_f32_e32 v42, v229, v42
    v_mul_f32_e32 v43, v229, v43
    v_cvt_pk_bf16_f32 v40, v40, v41
    v_cvt_pk_bf16_f32 v41, v42, v43
    ds_write_b64 v246, v[40:41] offset:4096
    v_mul_f32_e32 v44, v229, v44
    v_mul_f32_e32 v45, v229, v45
    v_mul_f32_e32 v46, v229, v46
    v_mul_f32_e32 v47, v229, v47
    v_cvt_pk_bf16_f32 v44, v44, v45
    v_cvt_pk_bf16_f32 v45, v46, v47
    ds_write_b64 v247, v[44:45] offset:4096
    v_mul_f32_e32 v48, v229, v48
    v_mul_f32_e32 v49, v229, v49
    v_mul_f32_e32 v50, v229, v50
    v_mul_f32_e32 v51, v229, v51
    v_cvt_pk_bf16_f32 v48, v48, v49
    v_cvt_pk_bf16_f32 v49, v50, v51
    ds_write_b64 v244, v[48:49] offset:4224
    v_mul_f32_e32 v52, v229, v52
    v_mul_f32_e32 v53, v229, v53
    v_mul_f32_e32 v54, v229, v54
    v_mul_f32_e32 v55, v229, v55
    v_cvt_pk_bf16_f32 v52, v52, v53
    v_cvt_pk_bf16_f32 v53, v54, v55
    ds_write_b64 v245, v[52:53] offset:4224
    v_mul_f32_e32 v56, v229, v56
    v_mul_f32_e32 v57, v229, v57
    v_mul_f32_e32 v58, v229, v58
    v_mul_f32_e32 v59, v229, v59
    v_cvt_pk_bf16_f32 v56, v56, v57
    v_cvt_pk_bf16_f32 v57, v58, v59
    ds_write_b64 v246, v[56:57] offset:4224
    v_mul_f32_e32 v60, v229, v60
    v_mul_f32_e32 v61, v229, v61
    v_mul_f32_e32 v62, v229, v62
    v_mul_f32_e32 v63, v229, v63
    v_cvt_pk_bf16_f32 v60, v60, v61
    v_cvt_pk_bf16_f32 v61, v62, v63
    ds_write_b64 v247, v[60:61] offset:4224
    v_mul_f32_e32 v64, v230, v64
    v_mul_f32_e32 v65, v230, v65
    v_mul_f32_e32 v66, v230, v66
    v_mul_f32_e32 v67, v230, v67
    v_cvt_pk_bf16_f32 v64, v64, v65
    v_cvt_pk_bf16_f32 v65, v66, v67
    ds_write_b64 v244, v[64:65] offset:8192
    v_mul_f32_e32 v68, v230, v68
    v_mul_f32_e32 v69, v230, v69
    v_mul_f32_e32 v70, v230, v70
    v_mul_f32_e32 v71, v230, v71
    v_cvt_pk_bf16_f32 v68, v68, v69
    v_cvt_pk_bf16_f32 v69, v70, v71
    ds_write_b64 v245, v[68:69] offset:8192
    v_mul_f32_e32 v72, v230, v72
    v_mul_f32_e32 v73, v230, v73
    v_mul_f32_e32 v74, v230, v74
    v_mul_f32_e32 v75, v230, v75
    v_cvt_pk_bf16_f32 v72, v72, v73
    v_cvt_pk_bf16_f32 v73, v74, v75
    ds_write_b64 v246, v[72:73] offset:8192
    v_mul_f32_e32 v76, v230, v76
    v_mul_f32_e32 v77, v230, v77
    v_mul_f32_e32 v78, v230, v78
    v_mul_f32_e32 v79, v230, v79
    v_cvt_pk_bf16_f32 v76, v76, v77
    v_cvt_pk_bf16_f32 v77, v78, v79
    ds_write_b64 v247, v[76:77] offset:8192
    v_mul_f32_e32 v80, v230, v80
    v_mul_f32_e32 v81, v230, v81
    v_mul_f32_e32 v82, v230, v82
    v_mul_f32_e32 v83, v230, v83
    v_cvt_pk_bf16_f32 v80, v80, v81
    v_cvt_pk_bf16_f32 v81, v82, v83
    ds_write_b64 v244, v[80:81] offset:8320
    v_mul_f32_e32 v84, v230, v84
    v_mul_f32_e32 v85, v230, v85
    v_mul_f32_e32 v86, v230, v86
    v_mul_f32_e32 v87, v230, v87
    v_cvt_pk_bf16_f32 v84, v84, v85
    v_cvt_pk_bf16_f32 v85, v86, v87
    ds_write_b64 v245, v[84:85] offset:8320
    v_mul_f32_e32 v88, v230, v88
    v_mul_f32_e32 v89, v230, v89
    v_mul_f32_e32 v90, v230, v90
    v_mul_f32_e32 v91, v230, v91
    v_cvt_pk_bf16_f32 v88, v88, v89
    v_cvt_pk_bf16_f32 v89, v90, v91
    ds_write_b64 v246, v[88:89] offset:8320
    v_mul_f32_e32 v92, v230, v92
    v_mul_f32_e32 v93, v230, v93
    v_mul_f32_e32 v94, v230, v94
    v_mul_f32_e32 v95, v230, v95
    v_cvt_pk_bf16_f32 v92, v92, v93
    v_cvt_pk_bf16_f32 v93, v94, v95
    ds_write_b64 v247, v[92:93] offset:8320
    v_mul_f32_e32 v96, v231, v96
    v_mul_f32_e32 v97, v231, v97
    v_mul_f32_e32 v98, v231, v98
    v_mul_f32_e32 v99, v231, v99
    v_cvt_pk_bf16_f32 v96, v96, v97
    v_cvt_pk_bf16_f32 v97, v98, v99
    ds_write_b64 v244, v[96:97] offset:12288
    v_mul_f32_e32 v100, v231, v100
    v_mul_f32_e32 v101, v231, v101
    v_mul_f32_e32 v102, v231, v102
    v_mul_f32_e32 v103, v231, v103
    v_cvt_pk_bf16_f32 v100, v100, v101
    v_cvt_pk_bf16_f32 v101, v102, v103
    ds_write_b64 v245, v[100:101] offset:12288
    v_mul_f32_e32 v104, v231, v104
    v_mul_f32_e32 v105, v231, v105
    v_mul_f32_e32 v106, v231, v106
    v_mul_f32_e32 v107, v231, v107
    v_cvt_pk_bf16_f32 v104, v104, v105
    v_cvt_pk_bf16_f32 v105, v106, v107
    ds_write_b64 v246, v[104:105] offset:12288
    v_mul_f32_e32 v108, v231, v108
    v_mul_f32_e32 v109, v231, v109
    v_mul_f32_e32 v110, v231, v110
    v_mul_f32_e32 v111, v231, v111
    v_cvt_pk_bf16_f32 v108, v108, v109
    v_cvt_pk_bf16_f32 v109, v110, v111
    ds_write_b64 v247, v[108:109] offset:12288
    v_mul_f32_e32 v112, v231, v112
    v_mul_f32_e32 v113, v231, v113
    v_mul_f32_e32 v114, v231, v114
    v_mul_f32_e32 v115, v231, v115
    v_cvt_pk_bf16_f32 v112, v112, v113
    v_cvt_pk_bf16_f32 v113, v114, v115
    ds_write_b64 v244, v[112:113] offset:12416
    v_mul_f32_e32 v116, v231, v116
    v_mul_f32_e32 v117, v231, v117
    v_mul_f32_e32 v118, v231, v118
    v_mul_f32_e32 v119, v231, v119
    v_cvt_pk_bf16_f32 v116, v116, v117
    v_cvt_pk_bf16_f32 v117, v118, v119
    ds_write_b64 v245, v[116:117] offset:12416
    v_mul_f32_e32 v120, v231, v120
    v_mul_f32_e32 v121, v231, v121
    v_mul_f32_e32 v122, v231, v122
    v_mul_f32_e32 v123, v231, v123
    v_cvt_pk_bf16_f32 v120, v120, v121
    v_cvt_pk_bf16_f32 v121, v122, v123
    ds_write_b64 v246, v[120:121] offset:12416
    v_mul_f32_e32 v124, v231, v124
    v_mul_f32_e32 v125, v231, v125
    v_mul_f32_e32 v126, v231, v126
    v_mul_f32_e32 v127, v231, v127
    v_cvt_pk_bf16_f32 v124, v124, v125
    v_cvt_pk_bf16_f32 v125, v126, v127
    ds_write_b64 v247, v[124:125] offset:12416
    s_waitcnt lgkmcnt(0)
    ds_read_b128 a[192:195], v241
    ds_read_b128 a[196:199], v242 offset:1024
    ds_read_b128 a[200:203], v241 offset:2048
    ds_read_b128 a[204:207], v242 offset:3072
    s_waitcnt lgkmcnt(3)
    buffer_store_dwordx4 a[192:195], v243, s[24:27], s32 offen sc1
    s_waitcnt lgkmcnt(2)
    buffer_store_dwordx4 a[196:199], v243, s[24:27], s32 offen offset:1024 sc1
    s_waitcnt lgkmcnt(1)
    buffer_store_dwordx4 a[200:203], v243, s[24:27], s32 offen offset:2048 sc1
    s_waitcnt lgkmcnt(0)
    buffer_store_dwordx4 a[204:207], v243, s[24:27], s32 offen offset:3072 sc1
    ds_read_b128 a[208:211], v241 offset:4096
    ds_read_b128 a[212:215], v242 offset:5120
    ds_read_b128 a[216:219], v241 offset:6144
    ds_read_b128 a[220:223], v242 offset:7168
    s_waitcnt lgkmcnt(3)
    buffer_store_dwordx4 a[208:211], v243, s[24:27], s33 offen sc1
    s_waitcnt lgkmcnt(2)
    buffer_store_dwordx4 a[212:215], v243, s[24:27], s33 offen offset:1024 sc1
    s_waitcnt lgkmcnt(1)
    buffer_store_dwordx4 a[216:219], v243, s[24:27], s33 offen offset:2048 sc1
    s_waitcnt lgkmcnt(0)
    buffer_store_dwordx4 a[220:223], v243, s[24:27], s33 offen offset:3072 sc1
    ds_read_b128 a[192:195], v241 offset:8192
    ds_read_b128 a[196:199], v242 offset:9216
    ds_read_b128 a[200:203], v241 offset:10240
    ds_read_b128 a[204:207], v242 offset:11264
    s_waitcnt lgkmcnt(3)
    buffer_store_dwordx4 a[192:195], v243, s[24:27], s34 offen sc1
    s_waitcnt lgkmcnt(2)
    buffer_store_dwordx4 a[196:199], v243, s[24:27], s34 offen offset:1024 sc1
    s_waitcnt lgkmcnt(1)
    buffer_store_dwordx4 a[200:203], v243, s[24:27], s34 offen offset:2048 sc1
    s_waitcnt lgkmcnt(0)
    buffer_store_dwordx4 a[204:207], v243, s[24:27], s34 offen offset:3072 sc1
    ds_read_b128 a[208:211], v241 offset:12288
    ds_read_b128 a[212:215], v242 offset:13312
    ds_read_b128 a[216:219], v241 offset:14336
    ds_read_b128 a[220:223], v242 offset:15360
    s_waitcnt lgkmcnt(3)
    buffer_store_dwordx4 a[208:211], v243, s[24:27], s35 offen sc1
    s_waitcnt lgkmcnt(2)
    buffer_store_dwordx4 a[212:215], v243, s[24:27], s35 offen offset:1024 sc1
    s_waitcnt lgkmcnt(1)
    buffer_store_dwordx4 a[216:219], v243, s[24:27], s35 offen offset:2048 sc1
    s_waitcnt lgkmcnt(0)
    buffer_store_dwordx4 a[220:223], v243, s[24:27], s35 offen offset:3072 sc1
    s_endpgm
.section .rodata,"a"
.p2align 6
.amdhsa_kernel standalone__mha_softmax__near_ridge_kernel
  .amdhsa_next_free_vgpr 512
  .amdhsa_next_free_sgpr 102
  .amdhsa_accum_offset 256
  .amdhsa_group_segment_fixed_size 0
  .amdhsa_kernarg_size 48
  .amdhsa_user_sgpr_count 2
  .amdhsa_user_sgpr_kernarg_segment_ptr 1
  .amdhsa_system_sgpr_workgroup_id_x 1
.end_amdhsa_kernel
```
